```python
import torch

def _softmax(x, axis=-1):
    return torch.softmax(x, dim=axis)
def _gelu(x):
    return torch.nn.functional.gelu(x, approximate="tanh")
def _silu(x):
    return torch.nn.functional.silu(x)
def _sigmoid(x):
    return torch.sigmoid(x)
def _layernorm(x, axis=-1, eps=1e-5):
    m = x.mean(dim=axis, keepdim=True)
    v = x.var(dim=axis, keepdim=True, unbiased=False)
    return (x - m) / torch.sqrt(v + eps)
def _scatter_add(tgt, idx, src, axis=0):
    return tgt.clone().index_add_(axis, idx, src)
def _segment_sum(src, seg, n):
    out = torch.zeros((n,) + src.shape[1:], dtype=src.dtype)
    return out.index_add_(0, seg, src)
def _pad(x, pw):
    flat = tuple(v for pair in reversed(pw) for v in pair)
    return torch.nn.functional.pad(x, flat)

kernel_name = 'recurrent_scan__spectral_fnet__mixer_s_mlp__prompt'

def setup_inputs():

    _w = (lambda a: (lambda t: t.to(torch.bfloat16) if t.is_floating_point() else t)(torch.as_tensor(a)))
    def _A_setup():
        B, S, D = 1, 2048, 512
        ns = torch.arange(S)[:, None] * torch.arange(S)[None, :]
        nd = torch.arange(D)[:, None] * torch.arange(D)[None, :]
        Ws_re = torch.cos(-2.0 * torch.pi * ns / S).to(float)
        Ws_im = torch.sin(-2.0 * torch.pi * ns / S).to(float)
        Wd_re = torch.cos(-2.0 * torch.pi * nd / D).to(float)
        Wd_im = torch.sin(-2.0 * torch.pi * nd / D).to(float)
        return {
            "x": _w((lambda *s: torch.randn(*s, dtype=torch.bfloat16) * 0.05)(B, S, D)),
            "dft_seq_re": _w(Ws_re),
            "dft_seq_im": _w(Ws_im),
            "dft_hid_re": _w(Wd_re),
            "dft_hid_im": _w(Wd_im),
        }
    _A_in = _A_setup()

    def _B_setup():
        B, S, D, F = 1, 2048, 512, 1376
        return {
            "x":  _w((lambda *s: torch.randn(*s, dtype=torch.bfloat16) * 0.05)(B, S, D)),
            "w1": _w((lambda *s: torch.randn(*s, dtype=torch.bfloat16) * 3.2)(D, D) * (D ** -0.5)),
            "w2": _w((lambda *s: torch.randn(*s, dtype=torch.bfloat16) * 3.2)(D, D) * (D ** -0.5)),
            "w3": _w((lambda *s: torch.randn(*s, dtype=torch.bfloat16) * 3.2)(D, F) * (D ** -0.5)),
            "w4": _w((lambda *s: torch.randn(*s, dtype=torch.bfloat16) * 3.2)(F, D) * (F ** -0.5)),
        }
    _B_in = _B_setup()

    return {
        "A_x": _A_in["x"],
        "A_dft_seq_re": _A_in["dft_seq_re"],
        "A_dft_seq_im": _A_in["dft_seq_im"],
        "A_dft_hid_re": _A_in["dft_hid_re"],
        "A_dft_hid_im": _A_in["dft_hid_im"],
        "B_x": _B_in["x"],
        "B_w1": _B_in["w1"],
        "B_w2": _B_in["w2"],
        "B_w3": _B_in["w3"],
        "B_w4": _B_in["w4"],
    }

def reference(A_x, A_dft_seq_re, A_dft_seq_im, A_dft_hid_re, A_dft_hid_im, B_x, B_w1, B_w2, B_w3, B_w4):
    def _A_ref(x, dft_seq_re, dft_seq_im, dft_hid_re, dft_hid_im):
        a = torch.einsum("bsd,ed->bse", x, dft_hid_re)
        b = torch.einsum("bsd,ed->bse", x, dft_hid_im)
        y = torch.einsum("ts,bse->bte", dft_seq_re, a) - torch.einsum("ts,bse->bte", dft_seq_im, b)
        return y

    def _B_ref(x, w1, w2, w3, w4):
        B, S, D = x.shape
        h = _gelu(_layernorm(x, axis=-1) @ w1)
        c = D // 4
        g0 = _pad(h[:, :, 0*c:1*c], ((0, 0), (1, 0), (0, 0)))[:, :S, :]
        g1 = _pad(h[:, :, 1*c:2*c], ((0, 0), (0, 1), (0, 0)))[:, 1:, :]
        g2 = _pad(h[:, :, 2*c:3*c], ((0, 0), (2, 0), (0, 0)))[:, :S, :]
        g3 = _pad(h[:, :, 3*c:   ], ((0, 0), (0, 2), (0, 0)))[:, 2:, :]
        hs = torch.concatenate([g0, g1, g2, g3], axis=-1) @ w2
        x1 = x + hs
        h2 = _gelu(_layernorm(x1, axis=-1) @ w3) @ w4
        return x1 + h2

    x = A_x
    xn = _layernorm(x, axis=-1)
    s = _A_ref(xn, A_dft_seq_re, A_dft_seq_im, A_dft_hid_re, A_dft_hid_im)
    g = _silu(_B_ref(xn, B_w1, B_w2, B_w3, B_w4))
    return x + s * g
```

```asm
; @launch grid=(256,1,1) block=(512,1,1) lds=163840
.amdgcn_target "amdgcn-amd-amdhsa--gfx950"
.text
.globl recurrent_scan__spectral_fnet__mixer_s_mlp__prompt_kernel
.p2align 8
.type recurrent_scan__spectral_fnet__mixer_s_mlp__prompt_kernel,@function
recurrent_scan__spectral_fnet__mixer_s_mlp__prompt_kernel:
    s_cmp_ge_u32 s2, 256
    s_cbranch_scc1 L_end
    s_load_dwordx2 s[4:5], s[0:1], 0
    s_load_dwordx2 s[28:29], s[0:1], 96
    s_load_dwordx2 s[8:9], s[0:1], 48
    s_load_dwordx2 s[32:33], s[0:1], 80
    v_lshrrev_b32 v1, 6, v0
    v_and_b32 v0, 63, v0
    s_and_b32 s50, s2, 7
    v_readfirstlane_b32 s40, v1
    s_lshr_b32 s51, s2, 3
    s_lshl_b32 s50, s50, 2
    s_lshr_b32 s52, s51, 3
    s_add_u32 s42, s50, s52
    s_and_b32 s43, s51, 7
    v_lshlrev_b32 v7, 4, v0
    s_and_b32 s41, s40, 3
    s_lshr_b32 s50, s43, 2
    s_add_u32 s50, s50, 1
    s_sub_u32 s51, 0, s50
    s_bitcmp1_b32 s43, 1
    s_cselect_b32 s44, s51, s50
    s_mov_b32 s6, 2097152
    s_mov_b32 s7, 0x20000
    s_mov_b32 s30, 268435456
    s_mov_b32 s31, 0x20000
    s_lshl_b32 s55, s42, 6
    s_sub_u32 s55, s55, s44
    s_lshl_b32 s50, s41, 4
    s_add_u32 s55, s55, s50
    s_lshl_b32 s53, s41, 14
    s_cmp_lt_u32 s40, 4
    s_cbranch_scc1 L_compute
    v_and_b32 v8, 15, v0
    v_lshrrev_b32 v9, 4, v0
    v_bfe_u32 v10, v0, 2, 2
    v_lshlrev_b32 v10, 6, v10
    s_and_b32 s47, s41, 1
    s_lshr_b32 s48, s41, 1
    s_lshr_b32 s45, s42, 1
    s_and_b32 s50, s42, 1
    s_lshl_b32 s50, s50, 3
    s_add_u32 s46, s50, s43
    s_lshl_b32 s49, s43, 7
    s_mov_b32 s54, 0x3f803f80
    s_cmp_gt_i32 s44, 0
    s_cselect_b32 s56, 64, -2
    s_add_u32 s56, s56, s47
    v_add_u32 v1, 0, v9
    v_xor_b32 v2, v1, v8
    v_add_u32 v1, s55, v1
    v_and_b32 v1, 2047, v1
    v_lshlrev_b32 v1, 10, v1
    v_lshl_add_u32 v20, v2, 4, v1
    v_add_u32 v1, 4, v9
    v_xor_b32 v2, v1, v8
    v_add_u32 v1, s55, v1
    v_and_b32 v1, 2047, v1
    v_lshlrev_b32 v1, 10, v1
    v_lshl_add_u32 v21, v2, 4, v1
    v_add_u32 v1, 8, v9
    v_xor_b32 v2, v1, v8
    v_add_u32 v1, s55, v1
    v_and_b32 v1, 2047, v1
    v_lshlrev_b32 v1, 10, v1
    v_lshl_add_u32 v22, v2, 4, v1
    v_add_u32 v1, 12, v9
    v_xor_b32 v2, v1, v8
    v_add_u32 v1, s55, v1
    v_and_b32 v1, 2047, v1
    v_lshlrev_b32 v1, 10, v1
    v_lshl_add_u32 v23, v2, 4, v1
    s_waitcnt lgkmcnt(0)
    s_add_u32 m0, s53, 0
    s_nop 0
    buffer_load_dwordx4 v20, s[4:7], 0 offen offset:0 lds
    s_add_u32 m0, s53, 1024
    s_nop 0
    buffer_load_dwordx4 v21, s[4:7], 0 offen offset:0 lds
    s_add_u32 m0, s53, 2048
    s_nop 0
    buffer_load_dwordx4 v22, s[4:7], 0 offen offset:0 lds
    s_add_u32 m0, s53, 3072
    s_nop 0
    buffer_load_dwordx4 v23, s[4:7], 0 offen offset:0 lds
    s_mov_b32 s10, 524288
    s_mov_b32 s11, 0x20000
    s_lshr_b32 s77, s2, 3
    s_lshl_b32 s77, s77, 2
    s_add_u32 s77, s77, s41
    v_lshlrev_b32 v12, 7, v0
    v_lshlrev_b32 v15, 10, v0
    v_lshrrev_b32 v3, 5, v0
    v_bfe_u32 v4, v0, 2, 2
    v_lshl_add_u32 v13, v3, 2, v4
    v_and_b32 v3, 1, v9
    v_lshlrev_b32 v3, 6, v3
    v_and_b32 v4, 3, v0
    v_lshl_add_u32 v14, v4, 4, v3
    v_lshl_add_u32 v24, v13, 10, v14
    v_xor_b32 v25, 16, v24
    v_add_u32 v25, 7168, v25
    v_add_u32 v26, 14336, v24
    v_add_u32 v27, 14336, v25
    s_lshl_b32 s79, s41, 12
    s_lshl_b32 s78, s41, 15
    s_add_u32 m0, s79, 65536
    s_add_u32 s78, s78, s49
    buffer_load_dwordx4 v24, s[8:11], s78 offen offset:0 lds
    buffer_load_dwordx4 v25, s[8:11], s78 offen offset:1024 lds
    buffer_load_dwordx4 v26, s[8:11], s78 offen offset:2048 lds
    buffer_load_dwordx4 v27, s[8:11], s78 offen offset:3072 lds
    s_add_u32 m0, s53, 3840
    s_nop 0
    buffer_load_dwordx4 v20, s[4:7], 0 offen offset:256 lds
    s_add_u32 m0, s53, 4864
    s_nop 0
    buffer_load_dwordx4 v21, s[4:7], 0 offen offset:256 lds
    s_add_u32 m0, s53, 5888
    s_nop 0
    buffer_load_dwordx4 v22, s[4:7], 0 offen offset:256 lds
    s_add_u32 m0, s53, 6912
    s_nop 0
    buffer_load_dwordx4 v23, s[4:7], 0 offen offset:256 lds
    s_load_dwordx2 s[12:13], s[0:1], 56
    s_load_dwordx2 s[16:17], s[0:1], 64
    s_load_dwordx2 s[20:21], s[0:1], 72
    s_load_dwordx4 s[36:39], s[0:1], 24
    s_load_dword s58, s[28:29], 0
    s_lshl_b32 s50, s47, 10
    s_add_u32 m0, s50, 156672
    s_lshl_b32 s51, s42, 6
    s_sub_u32 s51, s51, s44
    s_add_u32 s51, s51, s56
    s_and_b32 s51, s51, 2047
    s_lshl_b32 s51, s51, 10
    s_and_b32 s50, s56, 15
    s_lshl_b32 s50, s50, 4
    v_xor_b32 v1, s50, v7
    buffer_load_dwordx4 v1, s[4:7], s51 offen lds
    s_add_u32 m0, s79, 81920
    s_add_u32 s78, s78, 131072
    buffer_load_dwordx4 v24, s[8:11], s78 offen offset:0 lds
    buffer_load_dwordx4 v25, s[8:11], s78 offen offset:1024 lds
    buffer_load_dwordx4 v26, s[8:11], s78 offen offset:2048 lds
    buffer_load_dwordx4 v27, s[8:11], s78 offen offset:3072 lds
    s_lshl_b32 s50, s41, 4
    v_add_u32 v1, s50, v8
    v_add_u32 v3, s44, v1
    v_and_b32 v4, 1, v3
    v_lshlrev_b32 v4, 10, v4
    v_add_u32 v4, 156672, v4
    v_lshrrev_b32 v2, 4, v3
    v_lshlrev_b32 v2, 14, v2
    v_cmp_gt_u32 vcc, 64, v3
    v_and_b32 v3, 15, v3
    v_lshl_add_u32 v2, v3, 8, v2
    v_add_u32 v2, 0, v2
    v_cndmask_b32 v2, v4, v2, vcc
    v_mov_b32 v4, 256
    v_mov_b32 v18, 4096
    v_cndmask_b32 v18, v4, v18, vcc
    v_xor_b32 v1, v9, v3
    v_lshl_add_u32 v28, v1, 4, v2
    v_xor_b32 v5, v9, v8
    v_lshlrev_b32 v5, 4, v5
    v_lshl_add_u32 v1, v8, 8, v5
    v_add_u32 v32, 131072, v1
    v_xor_b32 v33, 64, v32
    v_xor_b32 v34, 128, v32
    v_xor_b32 v35, 192, v32
    v_lshl_add_u32 v5, v9, 11, v5
    s_waitcnt lgkmcnt(0)
    s_add_u32 s58, s58, 1
    s_mov_b32 s59, s58
    s_mov_b32 s14, 524288
    s_mov_b32 s15, 0x20000
    s_mov_b32 s18, 1409024
    s_mov_b32 s19, 0x20000
    s_mov_b32 s22, 1409024
    s_mov_b32 s23, 0x20000
    s_mov_b32 s26, 524288
    s_mov_b32 s27, 0x20000
    s_bitcmp1_b32 s41, 0
    s_cselect_b32 s24, s38, s36
    s_cselect_b32 s25, s39, s37
    s_lshl_b32 s76, s43, 5
    s_add_u32 s76, s76, s42
    s_add_u32 s76, s76, 1
    v_mov_b32 v16, 0
    v_mov_b32 v17, s58
    v_mov_b32 v36, 163712
    v_mov_b32 v37, 1
    s_mov_b64 exec, 1
    ds_write_b32 v36, v16
    s_mov_b64 exec, -1
    s_waitcnt vmcnt(9) lgkmcnt(0)
    s_barrier
    s_add_u32 m0, s53, 7680
    s_nop 0
    buffer_load_dwordx4 v20, s[4:7], 0 offen offset:512 lds
    s_add_u32 m0, s53, 8704
    s_nop 0
    buffer_load_dwordx4 v21, s[4:7], 0 offen offset:512 lds
    s_add_u32 m0, s53, 9728
    s_nop 0
    buffer_load_dwordx4 v22, s[4:7], 0 offen offset:512 lds
    s_add_u32 m0, s53, 10752
    s_nop 0
    buffer_load_dwordx4 v23, s[4:7], 0 offen offset:512 lds
    s_add_u32 m0, s79, 98304
    s_add_u32 s78, s78, 131072
    buffer_load_dwordx4 v24, s[8:11], s78 offen offset:0 lds
    buffer_load_dwordx4 v25, s[8:11], s78 offen offset:1024 lds
    buffer_load_dwordx4 v26, s[8:11], s78 offen offset:2048 lds
    buffer_load_dwordx4 v27, s[8:11], s78 offen offset:3072 lds
    s_waitcnt vmcnt(8) lgkmcnt(0)
    s_barrier
    s_add_u32 m0, s53, 11520
    s_nop 0
    buffer_load_dwordx4 v20, s[4:7], 0 offen offset:768 lds
    s_add_u32 m0, s53, 12544
    s_nop 0
    buffer_load_dwordx4 v21, s[4:7], 0 offen offset:768 lds
    s_add_u32 m0, s53, 13568
    s_nop 0
    buffer_load_dwordx4 v22, s[4:7], 0 offen offset:768 lds
    s_add_u32 m0, s53, 14592
    s_nop 0
    buffer_load_dwordx4 v23, s[4:7], 0 offen offset:768 lds
    s_add_u32 m0, s79, 114688
    s_add_u32 s78, s78, 131072
    buffer_load_dwordx4 v24, s[8:11], s78 offen offset:0 lds
    buffer_load_dwordx4 v25, s[8:11], s78 offen offset:1024 lds
    buffer_load_dwordx4 v26, s[8:11], s78 offen offset:2048 lds
    buffer_load_dwordx4 v27, s[8:11], s78 offen offset:3072 lds
    s_sub_u32 s50, s56, s44
    s_lshl_b32 s50, s50, 2
    s_add_u32 s50, s50, 162064
    v_mov_b32 v59, s50
    v_mov_b32 v60, 0
    v_mov_b32 v62, 0
    s_lshl_b32 s50, s47, 10
    s_add_u32 s50, s50, 156672
    v_add_u32 v1, s50, v7
    ds_read_b128 v[20:23], v1
    v_xor_b32 v29, 64, v28
    v_xor_b32 v30, 128, v28
    v_xor_b32 v31, 192, v28
    ds_read_b128 v[192:195], v28
    ds_read_b128 v[196:199], v29
    ds_read_b128 v[200:203], v30
    ds_read_b128 v[204:207], v31
    v_add_u32 v28, v28, v18
    v_xor_b32 v29, 64, v28
    v_xor_b32 v30, 128, v28
    v_xor_b32 v31, 192, v28
    ds_read_b128 v[208:211], v28
    ds_read_b128 v[212:215], v29
    ds_read_b128 v[216:219], v30
    ds_read_b128 v[220:223], v31
    s_waitcnt vmcnt(8) lgkmcnt(0)
    s_barrier
    s_cmp_lt_u32 s41, 2
    s_cselect_b32 s52, 2, 1
    s_lshl_b32 s78, s43, 5
    s_add_u32 s78, s78, s52
    s_add_u32 m0, s79, 131072
    s_lshl_b32 s78, s78, 10
    buffer_load_dwordx4 v5, s[24:27], s78 offen lds
    v_xor_b32 v2, 64, v5
    v_add_u32 v2, 7168, v2
    buffer_load_dwordx4 v2, s[24:27], s78 offen offset:1024 lds
    v_xor_b32 v1, 128, v5
    v_add_u32 v1, 14336, v1
    buffer_load_dwordx4 v1, s[24:27], s78 offen offset:2048 lds
    v_xor_b32 v2, 192, v5
    v_add_u32 v2, 21504, v2
    buffer_load_dwordx4 v2, s[24:27], s78 offen offset:3072 lds
    s_mul_i32 s52, s77, 4096
    s_mov_b32 s80, m0
    s_mov_b32 m0, 163744
    s_mov_b64 exec, 0xffff
    buffer_load_dword v12, s[12:15], s52 offen  lds
    s_mov_b64 exec, -1
    s_mov_b32 m0, s80
    s_mul_i32 s52, s77, 4096
    s_add_u32 s52, s52, 2048
    s_mov_b32 s80, m0
    s_mov_b32 m0, 163744
    s_mov_b64 exec, 0xffff
    buffer_load_dword v12, s[12:15], s52 offen  lds
    s_mov_b64 exec, -1
    s_mov_b32 m0, s80
    s_lshl_b32 s51, s2, 2
    s_add_u32 s51, s51, s41
    s_min_u32 s51, s51, 999
    s_mul_i32 s52, s51, 1408
    s_mov_b32 s80, m0
    s_mov_b32 m0, 163744
    s_mov_b64 exec, 0x7ff
    buffer_load_dword v12, s[16:19], s52 offen  lds
    s_mov_b64 exec, -1
    s_mov_b32 m0, s80
    s_mul_i32 s52, s51, 1408
    s_mov_b32 s80, m0
    s_mov_b32 m0, 163744
    s_mov_b64 exec, 0x7ff
    buffer_load_dword v12, s[20:23], s52 offen  lds
    s_mov_b64 exec, -1
    s_mov_b32 m0, s80
    v_lshlrev_b32 v1, 12, v0
    s_and_b32 s52, s77, 31
    s_lshl_b32 s52, s52, 7
    s_add_u32 s52, s52, 4096
    s_mov_b32 s80, m0
    s_mov_b32 m0, 163744
    s_mov_b64 exec, 0x7f
    buffer_load_dword v1, s[28:31], s52 offen  lds
    s_mov_b64 exec, -1
    s_mov_b32 m0, s80
    s_cmp_eq_u32 s41, 0
    s_cselect_b32 s50, s42, s45
    s_lshl_b32 s50, s50, 7
    s_lshl_b32 s51, s41, 12
    s_add_u32 s50, s50, s51
    s_add_u32 s50, s50, 4096
    v_add_u32 v28, v28, v18
    v_xor_b32 v29, 64, v28
    v_xor_b32 v30, 128, v28
    v_xor_b32 v31, 192, v28
    ds_read_b128 v[224:227], v28
    ds_read_b128 v[228:231], v29
    ds_read_b128 v[232:235], v30
    ds_read_b128 v[236:239], v31
    s_waitcnt vmcnt(9) lgkmcnt(0)
    s_barrier
    v_add_u32 v28, v28, v18
    v_xor_b32 v29, 64, v28
    v_xor_b32 v30, 128, v28
    v_xor_b32 v31, 192, v28
    ds_read_b128 v[240:243], v28
    ds_read_b128 v[244:247], v29
    ds_read_b128 v[248:251], v30
    ds_read_b128 v[252:255], v31
    s_lshl_b32 s78, s41, 17
    s_add_u32 s78, s78, s49
    s_add_u32 m0, s53, 0
    s_nop 0
    buffer_load_dwordx4 v24, s[12:15], s78 offen offset:0 lds
    buffer_load_dwordx4 v25, s[12:15], s78 offen offset:1024 lds
    buffer_load_dwordx4 v26, s[12:15], s78 offen offset:2048 lds
    buffer_load_dwordx4 v27, s[12:15], s78 offen offset:3072 lds
    s_waitcnt vmcnt(9) lgkmcnt(0)
    s_barrier
    ds_read_b128 v[128:131], v32 offset:0
    ds_read_b128 v[144:147], v32 offset:4096
    s_add_u32 s78, s78, 32768
    s_add_u32 m0, s53, 4096
    s_nop 0
    buffer_load_dwordx4 v24, s[12:15], s78 offen offset:0 lds
    ds_read_b128 v[160:163], v32 offset:8192
    buffer_load_dwordx4 v25, s[12:15], s78 offen offset:1024 lds
    ds_read_b128 v[176:179], v32 offset:12288
    buffer_load_dwordx4 v26, s[12:15], s78 offen offset:2048 lds
    ds_read_b128 v[132:135], v33 offset:0
    ds_read_b128 v[148:151], v33 offset:4096
    buffer_load_dwordx4 v27, s[12:15], s78 offen offset:3072 lds
    ds_read_b128 v[164:167], v33 offset:8192
    s_add_u32 s78, s78, 32768
    s_add_u32 m0, s53, 8192
    s_nop 0
    buffer_load_dwordx4 v24, s[12:15], s78 offen offset:0 lds
    ds_read_b128 v[180:183], v33 offset:12288
    buffer_load_dwordx4 v25, s[12:15], s78 offen offset:1024 lds
    ds_read_b128 v[136:139], v34 offset:0
    ds_read_b128 v[152:155], v34 offset:4096
    buffer_load_dwordx4 v26, s[12:15], s78 offen offset:2048 lds
    ds_read_b128 v[168:171], v34 offset:8192
    buffer_load_dwordx4 v27, s[12:15], s78 offen offset:3072 lds
    ds_read_b128 v[184:187], v34 offset:12288
    s_add_u32 s78, s78, 32768
    s_add_u32 m0, s53, 12288
    s_nop 0
    buffer_load_dwordx4 v24, s[12:15], s78 offen offset:0 lds
    ds_read_b128 v[140:143], v35 offset:0
    ds_read_b128 v[156:159], v35 offset:4096
    buffer_load_dwordx4 v25, s[12:15], s78 offen offset:1024 lds
    ds_read_b128 v[172:175], v35 offset:8192
    buffer_load_dwordx4 v26, s[12:15], s78 offen offset:2048 lds
    s_waitcnt lgkmcnt(14)
    ds_read_b128 v[188:191], v35 offset:12288
    buffer_load_dwordx4 v27, s[12:15], s78 offen offset:3072 lds
    s_lshl_b32 s50, s41, 6
    s_add_u32 s50, s50, 162064
    v_lshl_add_u32 v58, v9, 4, s50
    v_mov_b32 v48, s54
    v_mov_b32 v49, s54
    v_mov_b32 v50, s54
    v_mov_b32 v51, s54
    s_waitcnt lgkmcnt(0)
    v_dot2c_f32_bf16 v60, s54, v20
    v_dot2c_f32_bf16 v62, v20, v20
    v_dot2c_f32_bf16 v60, s54, v21
    v_dot2c_f32_bf16 v62, v21, v21
    v_dot2c_f32_bf16 v60, s54, v22
    v_dot2c_f32_bf16 v62, v22, v22
    v_dot2c_f32_bf16 v60, s54, v23
    v_dot2c_f32_bf16 v62, v23, v23
    v_mfma_f32_16x16x32_bf16 v[112:115], v[192:195], v[128:131], 0
    s_movk_i32 s50, 2752
    v_mfma_f32_16x16x32_bf16 v[120:123], v[192:195], v[144:147], 0
    v_mul_u32_u24 v1, s50, v13
    v_add_u32 v52, v1, v14
    v_mfma_f32_16x16x32_bf16 v[80:83], v[192:195], v[160:163], 0
    v_add_u32 v53, 20992, v52
    v_add_u32 v54, 41984, v52
    v_mfma_f32_16x16x32_bf16 v[96:99], v[192:195], v[176:179], 0
    v_add_u32 v55, 62976, v52
    s_mul_i32 s81, s41, 352256
    v_mfma_f32_16x16x32_bf16 v[28:31], v[48:51], v[128:131], 0
    s_lshl_b32 s50, s46, 7
    s_add_u32 s81, s81, s50
    v_mfma_f32_16x16x32_bf16 v[32:35], v[48:51], v[144:147], 0
    s_add_u32 m0, s53, 65536
    s_nop 0
    buffer_load_dwordx4 v52, s[16:19], s81 offen offset:0 lds
    buffer_load_dwordx4 v53, s[16:19], s81 offen offset:1024 lds
    v_mfma_f32_16x16x32_bf16 v[112:115], v[196:199], v[132:135], v[112:115]
    buffer_load_dwordx4 v54, s[16:19], s81 offen offset:2048 lds
    v_mfma_f32_16x16x32_bf16 v[120:123], v[196:199], v[148:151], v[120:123]
    buffer_load_dwordx4 v55, s[16:19], s81 offen offset:3072 lds
    s_add_u32 m0, m0, 4096
    s_add_u32 s81, s81, 88064
    buffer_load_dwordx4 v52, s[16:19], s81 offen offset:0 lds
    v_mfma_f32_16x16x32_bf16 v[80:83], v[196:199], v[164:167], v[80:83]
    buffer_load_dwordx4 v53, s[16:19], s81 offen offset:1024 lds
    buffer_load_dwordx4 v54, s[16:19], s81 offen offset:2048 lds
    v_mfma_f32_16x16x32_bf16 v[96:99], v[196:199], v[180:183], v[96:99]
    buffer_load_dwordx4 v55, s[16:19], s81 offen offset:3072 lds
    v_mov_b32 v61, v60
    v_mfma_f32_16x16x32_bf16 v[28:31], v[48:51], v[132:135], v[28:31]
    v_mov_b32 v63, v62
    v_permlane32_swap_b32 v60, v61
    v_mfma_f32_16x16x32_bf16 v[32:35], v[48:51], v[148:151], v[32:35]
    v_permlane32_swap_b32 v62, v63
    v_add_f32 v60, v60, v61
    v_mfma_f32_16x16x32_bf16 v[112:115], v[200:203], v[136:139], v[112:115]
    v_add_f32 v62, v62, v63
    v_mfma_f32_16x16x32_bf16 v[120:123], v[200:203], v[152:155], v[120:123]
    v_mov_b32 v61, v60
    v_mov_b32 v63, v62
    v_mfma_f32_16x16x32_bf16 v[80:83], v[200:203], v[168:171], v[80:83]
    v_permlane16_swap_b32 v60, v61
    v_permlane16_swap_b32 v62, v63
    v_mfma_f32_16x16x32_bf16 v[96:99], v[200:203], v[184:187], v[96:99]
    v_add_f32 v60, v60, v61
    v_add_f32 v62, v62, v63
    v_mfma_f32_16x16x32_bf16 v[28:31], v[48:51], v[136:139], v[28:31]
    v_add_f32_dpp v60, v60, v60 row_ror:8 row_mask:0xf bank_mask:0xf
    v_add_f32_dpp v62, v62, v62 row_ror:8 row_mask:0xf bank_mask:0xf
    v_mfma_f32_16x16x32_bf16 v[32:35], v[48:51], v[152:155], v[32:35]
    v_add_f32_dpp v60, v60, v60 row_ror:4 row_mask:0xf bank_mask:0xf
    v_add_f32_dpp v62, v62, v62 row_ror:4 row_mask:0xf bank_mask:0xf
    v_mfma_f32_16x16x32_bf16 v[112:115], v[204:207], v[140:143], v[112:115]
    v_add_f32_dpp v60, v60, v60 row_ror:2 row_mask:0xf bank_mask:0xf
    v_mfma_f32_16x16x32_bf16 v[120:123], v[204:207], v[156:159], v[120:123]
    v_add_f32_dpp v62, v62, v62 row_ror:2 row_mask:0xf bank_mask:0xf
    v_add_f32_dpp v60, v60, v60 row_ror:1 row_mask:0xf bank_mask:0xf
    v_mfma_f32_16x16x32_bf16 v[80:83], v[204:207], v[172:175], v[80:83]
    v_add_f32_dpp v62, v62, v62 row_ror:1 row_mask:0xf bank_mask:0xf
    v_mul_f32 v60, 0x3b000000, v60
    v_mfma_f32_16x16x32_bf16 v[96:99], v[204:207], v[188:191], v[96:99]
    v_mul_f32 v62, 0x3b000000, v62
    v_fma_f32 v62, -v60, v60, v62
    v_mfma_f32_16x16x32_bf16 v[28:31], v[48:51], v[140:143], v[28:31]
    v_max_f32 v62, 0, v62
    v_add_f32 v62, 0x3727c5ac, v62
    v_mfma_f32_16x16x32_bf16 v[32:35], v[48:51], v[156:159], v[32:35]
    v_rsq_f32 v62, v62
    s_mov_b64 exec, 1
    ds_write_b32 v59, v60
    ds_write_b32 v59, v62 offset:288
    s_mov_b64 exec, -1
    s_barrier
    s_waitcnt vmcnt(8) lgkmcnt(0)
    s_barrier
    ds_read_b128 v[40:43], v58
    ds_read_b128 v[44:47], v58 offset:288
    v_mfma_f32_16x16x32_bf16 v[116:119], v[208:211], v[128:131], 0
    v_mfma_f32_16x16x32_bf16 v[124:127], v[208:211], v[144:147], 0
    s_add_u32 m0, m0, 4096
    s_add_u32 s81, s81, 88064
    buffer_load_dwordx4 v52, s[16:19], s81 offen offset:0 lds
    v_mfma_f32_16x16x32_bf16 v[84:87], v[208:211], v[160:163], 0
    buffer_load_dwordx4 v53, s[16:19], s81 offen offset:1024 lds
    v_mfma_f32_16x16x32_bf16 v[100:103], v[208:211], v[176:179], 0
    buffer_load_dwordx4 v54, s[16:19], s81 offen offset:2048 lds
    v_mfma_f32_16x16x32_bf16 v[116:119], v[212:215], v[132:135], v[116:119]
    buffer_load_dwordx4 v55, s[16:19], s81 offen offset:3072 lds
    v_mfma_f32_16x16x32_bf16 v[124:127], v[212:215], v[148:151], v[124:127]
    v_mfma_f32_16x16x32_bf16 v[84:87], v[212:215], v[164:167], v[84:87]
    s_add_u32 m0, m0, 4096
    s_add_u32 s81, s81, 88064
    buffer_load_dwordx4 v52, s[16:19], s81 offen offset:0 lds
    v_mfma_f32_16x16x32_bf16 v[100:103], v[212:215], v[180:183], v[100:103]
    buffer_load_dwordx4 v53, s[16:19], s81 offen offset:1024 lds
    v_mfma_f32_16x16x32_bf16 v[116:119], v[216:219], v[136:139], v[116:119]
    buffer_load_dwordx4 v54, s[16:19], s81 offen offset:2048 lds
    v_mfma_f32_16x16x32_bf16 v[124:127], v[216:219], v[152:155], v[124:127]
    buffer_load_dwordx4 v55, s[16:19], s81 offen offset:3072 lds
    v_mfma_f32_16x16x32_bf16 v[84:87], v[216:219], v[168:171], v[84:87]
    v_mfma_f32_16x16x32_bf16 v[100:103], v[216:219], v[184:187], v[100:103]
    v_and_b32 v2, 1, v0
    v_mfma_f32_16x16x32_bf16 v[116:119], v[220:223], v[140:143], v[116:119]
    v_lshlrev_b32 v2, 31, v2
    v_mfma_f32_16x16x32_bf16 v[124:127], v[220:223], v[156:159], v[124:127]
    v_xor_b32 v38, 0xbf800000, v2
    v_mfma_f32_16x16x32_bf16 v[84:87], v[220:223], v[172:175], v[84:87]
    v_add_f32 v39, 1.0, v38
    v_mfma_f32_16x16x32_bf16 v[100:103], v[220:223], v[188:191], v[100:103]
    v_mul_f32 v39, -2.0, v39
    v_mfma_f32_16x16x32_bf16 v[112:115], v[224:227], v[128:131], v[112:115]
    v_mfma_f32_16x16x32_bf16 v[120:123], v[224:227], v[144:147], v[120:123]
    s_movk_i32 s50, 144
    v_mfma_f32_16x16x32_bf16 v[88:91], v[224:227], v[160:163], 0
    v_mul_u32_u24 v3, s50, v8
    v_mfma_f32_16x16x32_bf16 v[104:107], v[224:227], v[176:179], 0
    v_lshl_add_u32 v3, v9, 3, v3
    v_mfma_f32_16x16x32_bf16 v[112:115], v[228:231], v[132:135], v[112:115]
    s_lshl_b32 s51, s41, 5
    v_mfma_f32_16x16x32_bf16 v[120:123], v[228:231], v[148:151], v[120:123]
    v_mfma_f32_16x16x32_bf16 v[88:91], v[228:231], v[164:167], v[88:91]
    s_add_u32 s51, s51, 147456
    v_mfma_f32_16x16x32_bf16 v[104:107], v[228:231], v[180:183], v[104:107]
    v_add_u32 v19, s51, v3
    v_mfma_f32_16x16x32_bf16 v[112:115], v[232:235], v[136:139], v[112:115]
    v_lshrrev_b32 v4, 3, v0
    v_mfma_f32_16x16x32_bf16 v[120:123], v[232:235], v[152:155], v[120:123]
    v_lshrrev_b32 v5, 1, v4
    v_mfma_f32_16x16x32_bf16 v[88:91], v[232:235], v[168:171], v[88:91]
    v_mfma_f32_16x16x32_bf16 v[104:107], v[232:235], v[184:187], v[104:107]
    s_lshl_b32 s51, s41, 2
    v_mfma_f32_16x16x32_bf16 v[112:115], v[236:239], v[140:143], v[112:115]
    v_add_u32 v5, s51, v5
    v_mfma_f32_16x16x32_bf16 v[120:123], v[236:239], v[156:159], v[120:123]
    v_and_b32 v6, 1, v4
    v_mfma_f32_16x16x32_bf16 v[88:91], v[236:239], v[172:175], v[88:91]
    v_xor_b32 v6, 1, v6
    v_mfma_f32_16x16x32_bf16 v[104:107], v[236:239], v[188:191], v[104:107]
    v_lshl_add_u32 v5, v6, 5, v5
    v_mfma_f32_16x16x32_bf16 v[116:119], v[240:243], v[128:131], v[116:119]
    v_mfma_f32_16x16x32_bf16 v[124:127], v[240:243], v[144:147], v[124:127]
    v_mul_u32_u24 v5, s50, v5
    v_mfma_f32_16x16x32_bf16 v[92:95], v[240:243], v[160:163], 0
    v_and_b32 v6, 7, v0
    v_mfma_f32_16x16x32_bf16 v[108:111], v[240:243], v[176:179], 0
    v_lshl_add_u32 v5, v6, 4, v5
    v_mfma_f32_16x16x32_bf16 v[116:119], v[244:247], v[132:135], v[116:119]
    v_add_u32 v56, 147456, v5
    v_mfma_f32_16x16x32_bf16 v[124:127], v[244:247], v[148:151], v[124:127]
    v_mfma_f32_16x16x32_bf16 v[92:95], v[244:247], v[164:167], v[92:95]
    v_lshlrev_b32 v4, 13, v4
    v_mfma_f32_16x16x32_bf16 v[108:111], v[244:247], v[180:183], v[108:111]
    v_lshl_add_u32 v57, v6, 4, v4
    v_mfma_f32_16x16x32_bf16 v[116:119], v[248:251], v[136:139], v[116:119]
    s_lshl_b32 s50, s43, 2
    v_mfma_f32_16x16x32_bf16 v[124:127], v[248:251], v[152:155], v[124:127]
    s_add_u32 s50, s50, s41
    v_mfma_f32_16x16x32_bf16 v[92:95], v[248:251], v[168:171], v[92:95]
    v_mfma_f32_16x16x32_bf16 v[108:111], v[248:251], v[184:187], v[108:111]
    s_lshl_b32 s50, s50, 16
    v_mfma_f32_16x16x32_bf16 v[116:119], v[252:255], v[140:143], v[116:119]
    s_lshl_b32 s51, s42, 7
    v_mfma_f32_16x16x32_bf16 v[124:127], v[252:255], v[156:159], v[124:127]
    s_add_u32 s50, s50, s51
    v_mfma_f32_16x16x32_bf16 v[92:95], v[252:255], v[172:175], v[92:95]
    s_add_u32 s82, s50, 11534336
    v_mfma_f32_16x16x32_bf16 v[108:111], v[252:255], v[188:191], v[108:111]
    s_add_u32 s83, s82, 4096
    s_barrier
    s_waitcnt lgkmcnt(0)
    v_mul_f32 v48, v39, v28
    v_mul_f32 v50, v39, v32
    v_pk_fma_f32 v[112:113], v[116:117], v[38:39], v[112:113] op_sel_hi:[1,0,1]
    v_pk_fma_f32 v[120:121], v[124:125], v[38:39], v[120:121] op_sel_hi:[1,0,1]
    v_pk_fma_f32 v[112:113], v[40:41], v[48:49], v[112:113] op_sel_hi:[1,0,1]
    v_pk_fma_f32 v[120:121], v[40:41], v[50:51], v[120:121] op_sel_hi:[1,0,1]
    v_pk_mul_f32 v[112:113], v[112:113], v[44:45]
    v_pk_mul_f32 v[120:121], v[120:121], v[44:45]
    v_cvt_pk_bf16_f32 v20, v112, v113
    v_cvt_pk_bf16_f32 v22, v120, v121
    v_pk_fma_f32 v[114:115], v[118:119], v[38:39], v[114:115] op_sel_hi:[1,0,1]
    v_pk_fma_f32 v[122:123], v[126:127], v[38:39], v[122:123] op_sel_hi:[1,0,1]
    v_pk_fma_f32 v[114:115], v[42:43], v[48:49], v[114:115] op_sel_hi:[1,0,1]
    v_pk_fma_f32 v[122:123], v[42:43], v[50:51], v[122:123] op_sel_hi:[1,0,1]
    v_pk_mul_f32 v[114:115], v[114:115], v[46:47]
    v_pk_mul_f32 v[122:123], v[122:123], v[46:47]
    v_cvt_pk_bf16_f32 v21, v114, v115
    v_cvt_pk_bf16_f32 v23, v122, v123
    v_pk_add_f32 v[80:81], v[80:81], v[88:89] neg_lo:[0,1] neg_hi:[0,1]
    v_pk_add_f32 v[96:97], v[96:97], v[104:105] neg_lo:[0,1] neg_hi:[0,1]
    v_pk_add_f32 v[100:101], v[100:101], v[108:109] neg_lo:[0,1] neg_hi:[0,1]
    v_pk_add_f32 v[84:85], v[84:85], v[92:93] neg_lo:[0,1] neg_hi:[0,1]
    v_pk_fma_f32 v[80:81], v[100:101], v[38:39], v[80:81] op_sel_hi:[1,0,1] neg_lo:[0,1,0] neg_hi:[0,1,0]
    v_pk_fma_f32 v[96:97], v[84:85], v[38:39], v[96:97] op_sel_hi:[1,0,1]
    v_pk_mul_f32 v[80:81], v[80:81], v[44:45]
    v_pk_mul_f32 v[96:97], v[96:97], v[44:45]
    v_cvt_pk_bf16_f32 v24, v80, v81
    v_cvt_pk_bf16_f32 v26, v96, v97
    v_pk_add_f32 v[82:83], v[82:83], v[90:91] neg_lo:[0,1] neg_hi:[0,1]
    v_pk_add_f32 v[98:99], v[98:99], v[106:107] neg_lo:[0,1] neg_hi:[0,1]
    v_pk_add_f32 v[102:103], v[102:103], v[110:111] neg_lo:[0,1] neg_hi:[0,1]
    v_pk_add_f32 v[86:87], v[86:87], v[94:95] neg_lo:[0,1] neg_hi:[0,1]
    v_pk_fma_f32 v[82:83], v[102:103], v[38:39], v[82:83] op_sel_hi:[1,0,1] neg_lo:[0,1,0] neg_hi:[0,1,0]
    v_pk_fma_f32 v[98:99], v[86:87], v[38:39], v[98:99] op_sel_hi:[1,0,1]
    v_pk_mul_f32 v[82:83], v[82:83], v[46:47]
    v_pk_mul_f32 v[98:99], v[98:99], v[46:47]
    v_cvt_pk_bf16_f32 v25, v82, v83
    v_cvt_pk_bf16_f32 v27, v98, v99
    ds_write_b64 v19, v[20:21] offset:0
    ds_write_b64 v19, v[22:23] offset:2304
    ds_write_b64 v19, v[24:25] offset:4608
    ds_write_b64 v19, v[26:27] offset:6912
    s_waitcnt lgkmcnt(0)
    s_mov_b64 exec, 1
    ds_add_u32 v36, v37
    s_mov_b64 exec, -1
    v_and_b32 v1, 1, v0
    v_lshlrev_b32 v1, 5, v1
    v_bfe_u32 v2, v0, 1, 1
    v_lshl_add_u32 v1, v2, 3, v1
    v_and_b32 v2, 1, v9
    v_lshl_add_u32 v1, v2, 4, v1
    v_add_u32 v1, v1, v10
    v_lshrrev_b32 v3, 5, v0
    v_lshl_add_u32 v18, v3, 10, v1
    v_lshl_add_u32 v19, v3, 9, v1
    s_add_u32 s50, s53, 65536
    v_add_u32 v18, s50, v18
    s_lshl_b32 s50, s41, 13
    v_add_u32 v19, s50, v19
    v_cmp_eq_u32 vcc, v2, v8
    v_mov_b32 v4, s54
    s_nop 0
    v_cndmask_b32 v32, 0, v4, vcc
    v_mov_b32 v33, v32
    v_mov_b32 v34, v32
    v_mov_b32 v35, v32
    v_bfe_u32 v1, v0, 2, 1
    v_lshlrev_b32 v1, 6, v1
    v_bfe_u32 v4, v0, 3, 1
    v_lshl_add_u32 v1, v4, 4, v1
    v_and_b32 v4, 3, v0
    v_lshl_add_u32 v28, v4, 2, v1
    s_mul_i32 s50, s41, 384
    s_add_u32 s50, s50, 161792
    v_add_u32 v28, s50, v28
    v_lshlrev_b32 v29, 2, v0
    v_add_u32 v29, 161792, v29
    s_lshl_b32 s50, s48, 6
    v_xor_b32 v1, s50, v14
    v_lshl_add_u32 v40, v13, 10, v1
    v_add_u32 v41, 7168, v40
    v_add_u32 v42, 14336, v40
    v_add_u32 v43, 21504, v40
    s_lshl_b32 s84, s48, 19
    s_add_u32 s84, s84, s49
    s_mul_i32 s85, s48, 180224
    s_add_u32 s85, s85, s49
    s_add_u32 s85, s85, 524288
    s_movk_i32 s50, 2752
    v_lshrrev_b32 v1, 2, v0
    v_mul_u32_u24 v1, s50, v1
    v_lshl_add_u32 v44, v4, 4, v1
    s_cmp_lt_u32 s46, 11
    s_cselect_b32 s51, 0, 0x10000000
    v_add_u32 v44, s51, v44
    v_add_u32 v45, 43008, v44
    v_add_u32 v46, 86016, v44
    v_add_u32 v47, 129024, v44
    s_mul_i32 s87, s41, 352256
    s_min_u32 s50, s46, 10
    s_lshl_b32 s50, s50, 6
    s_add_u32 s87, s87, s50
    s_add_u32 s87, s87, 2048
    s_lshl_b32 s50, s41, 13
    s_add_u32 m0, s50, 0
    s_nop 0
    buffer_load_dwordx4 v44, s[16:19], s87 offen offset:0 lds
    buffer_load_dwordx4 v45, s[16:19], s87 offen offset:1024 lds
    buffer_load_dwordx4 v46, s[16:19], s87 offen offset:2048 lds
    buffer_load_dwordx4 v47, s[16:19], s87 offen offset:3072 lds
    s_add_u32 m0, m0, 4096
    s_add_u32 s87, s87, 176128
    buffer_load_dwordx4 v44, s[16:19], s87 offen offset:0 lds
    buffer_load_dwordx4 v45, s[16:19], s87 offen offset:1024 lds
    buffer_load_dwordx4 v46, s[16:19], s87 offen offset:2048 lds
    buffer_load_dwordx4 v47, s[16:19], s87 offen offset:3072 lds
    s_min_u32 s50, s77, 124
    s_mul_i32 s50, s50, 11264
    s_add_u32 s50, s50, 384
    s_mov_b32 s80, m0
    s_mov_b32 m0, 163744
    s_mov_b64 exec, 0x7ff
    buffer_load_dword v15, s[20:23], s50 offen  lds
    s_mov_b64 exec, -1
    s_mov_b32 m0, s80
    s_waitcnt vmcnt(1) lgkmcnt(0)
    s_barrier
    ds_read_b128 v[20:23], v56
    ds_read_b128 v[24:27], v56 offset:2304
    s_waitcnt lgkmcnt(0)
    buffer_store_dwordx4 v[20:23], v57, s[28:31], s82 offen sc1
    buffer_store_dwordx4 v[24:27], v57, s[28:31], s83 offen sc1
    ds_read_b64_tr_b16 v[144:145], v18 offset:0
    ds_read_b64_tr_b16 v[146:147], v18 offset:512
    ds_read_b64_tr_b16 v[148:149], v18 offset:256
    ds_read_b64_tr_b16 v[150:151], v18 offset:768
    ds_read_b64_tr_b16 v[152:153], v19 offset:0
    ds_read_b64_tr_b16 v[154:155], v19 offset:256
    ds_read_b64_tr_b16 v[156:157], v18 offset:2048
    ds_read_b64_tr_b16 v[158:159], v18 offset:2560
    ds_read_b64_tr_b16 v[160:161], v18 offset:2304
    ds_read_b64_tr_b16 v[162:163], v18 offset:2816
    ds_read_b64_tr_b16 v[164:165], v19 offset:1024
    ds_read_b64_tr_b16 v[166:167], v19 offset:1280
    ds_read_b64_tr_b16 v[168:169], v18 offset:4096
    ds_read_b64_tr_b16 v[170:171], v18 offset:4608
    s_waitcnt lgkmcnt(10)
    v_mfma_f32_16x16x32_bf16 v[84:87], v[32:35], v[144:147], 0
    ds_read_b64_tr_b16 v[172:173], v18 offset:4352
    ds_read_b64_tr_b16 v[174:175], v18 offset:4864
    v_mfma_f32_16x16x32_bf16 v[88:91], v[32:35], v[148:151], 0
    ds_read_b64_tr_b16 v[144:145], v19 offset:2048
    ds_read_b64_tr_b16 v[146:147], v19 offset:2304
    s_waitcnt lgkmcnt(10)
    v_mfma_f32_16x16x32_bf16 v[92:95], v[32:35], v[152:155], 0
    ds_read_b64_tr_b16 v[148:149], v18 offset:6144
    ds_read_b64_tr_b16 v[150:151], v18 offset:6656
    v_mfma_f32_16x16x32_bf16 v[84:87], v[32:35], v[156:159], v[84:87]
    ds_read_b64_tr_b16 v[152:153], v18 offset:6400
    ds_read_b64_tr_b16 v[154:155], v18 offset:6912
    s_waitcnt lgkmcnt(10)
    v_mfma_f32_16x16x32_bf16 v[88:91], v[32:35], v[160:163], v[88:91]
    ds_read_b64_tr_b16 v[156:157], v19 offset:3072
    ds_read_b64_tr_b16 v[158:159], v19 offset:3328
    v_mfma_f32_16x16x32_bf16 v[92:95], v[32:35], v[164:167], v[92:95]
    ds_read_b64_tr_b16 v[160:161], v18 offset:8192
    ds_read_b64_tr_b16 v[162:163], v18 offset:8704
    s_waitcnt lgkmcnt(10)
    v_mfma_f32_16x16x32_bf16 v[84:87], v[32:35], v[168:171], v[84:87]
    ds_read_b64_tr_b16 v[164:165], v18 offset:8448
    ds_read_b64_tr_b16 v[166:167], v18 offset:8960
    v_mfma_f32_16x16x32_bf16 v[88:91], v[32:35], v[172:175], v[88:91]
    ds_read_b64_tr_b16 v[168:169], v19 offset:4096
    ds_read_b64_tr_b16 v[170:171], v19 offset:4352
    s_waitcnt lgkmcnt(10)
    v_mfma_f32_16x16x32_bf16 v[92:95], v[32:35], v[144:147], v[92:95]
    ds_read_b64_tr_b16 v[172:173], v18 offset:10240
    ds_read_b64_tr_b16 v[174:175], v18 offset:10752
    v_mfma_f32_16x16x32_bf16 v[84:87], v[32:35], v[148:151], v[84:87]
    ds_read_b64_tr_b16 v[144:145], v18 offset:10496
    ds_read_b64_tr_b16 v[146:147], v18 offset:11008
    s_waitcnt lgkmcnt(10)
    v_mfma_f32_16x16x32_bf16 v[88:91], v[32:35], v[152:155], v[88:91]
    ds_read_b64_tr_b16 v[148:149], v19 offset:5120
    ds_read_b64_tr_b16 v[150:151], v19 offset:5376
    v_mfma_f32_16x16x32_bf16 v[92:95], v[32:35], v[156:159], v[92:95]
    ds_read_b64_tr_b16 v[152:153], v18 offset:12288
    ds_read_b64_tr_b16 v[154:155], v18 offset:12800
    s_waitcnt lgkmcnt(10)
    v_mfma_f32_16x16x32_bf16 v[84:87], v[32:35], v[160:163], v[84:87]
    ds_read_b64_tr_b16 v[156:157], v18 offset:12544
    ds_read_b64_tr_b16 v[158:159], v18 offset:13056
    v_mfma_f32_16x16x32_bf16 v[88:91], v[32:35], v[164:167], v[88:91]
    ds_read_b64_tr_b16 v[160:161], v19 offset:6144
    ds_read_b64_tr_b16 v[162:163], v19 offset:6400
    s_waitcnt lgkmcnt(10)
    v_mfma_f32_16x16x32_bf16 v[92:95], v[32:35], v[168:171], v[92:95]
    ds_read_b64_tr_b16 v[164:165], v18 offset:14336
    ds_read_b64_tr_b16 v[166:167], v18 offset:14848
    v_mfma_f32_16x16x32_bf16 v[84:87], v[32:35], v[172:175], v[84:87]
    ds_read_b64_tr_b16 v[168:169], v18 offset:14592
    ds_read_b64_tr_b16 v[170:171], v18 offset:15104
    s_waitcnt lgkmcnt(10)
    v_mfma_f32_16x16x32_bf16 v[88:91], v[32:35], v[144:147], v[88:91]
    ds_read_b64_tr_b16 v[172:173], v19 offset:7168
    ds_read_b64_tr_b16 v[174:175], v19 offset:7424
    v_mfma_f32_16x16x32_bf16 v[92:95], v[32:35], v[148:151], v[92:95]
    s_waitcnt lgkmcnt(8)
    v_mfma_f32_16x16x32_bf16 v[84:87], v[32:35], v[152:155], v[84:87]
    v_mfma_f32_16x16x32_bf16 v[88:91], v[32:35], v[156:159], v[88:91]
    s_waitcnt lgkmcnt(4)
    v_mfma_f32_16x16x32_bf16 v[92:95], v[32:35], v[160:163], v[92:95]
    v_mfma_f32_16x16x32_bf16 v[84:87], v[32:35], v[164:167], v[84:87]
    s_waitcnt lgkmcnt(0)
    v_mfma_f32_16x16x32_bf16 v[88:91], v[32:35], v[168:171], v[88:91]
    v_mfma_f32_16x16x32_bf16 v[92:95], v[32:35], v[172:175], v[92:95]
    s_mov_b64 exec, 0xffff
    s_nop 3
    ds_write_b32 v28, v84 offset:0
    ds_write_b32 v28, v85 offset:32
    ds_write_b32 v28, v88 offset:128
    ds_write_b32 v28, v89 offset:160
    ds_write_b32 v28, v92 offset:256
    ds_write_b32 v28, v93 offset:288
    s_mov_b64 exec, -1
    s_waitcnt lgkmcnt(0)
    s_barrier
    ds_read_b32 v84, v29 offset:0
    ds_read_b32 v85, v29 offset:384
    ds_read_b32 v86, v29 offset:768
    ds_read_b32 v87, v29 offset:1152
    s_waitcnt lgkmcnt(0)
    v_add_f32 v84, v84, v85
    v_add_f32 v86, v86, v87
    v_add_f32 v84, v84, v86
    ds_write_b32 v29, v84 offset:1536
    s_mov_b64 exec, -1
    ds_read_b32 v84, v29 offset:256
    ds_read_b32 v85, v29 offset:640
    ds_read_b32 v86, v29 offset:1024
    ds_read_b32 v87, v29 offset:1408
    s_waitcnt lgkmcnt(0)
    v_add_f32 v84, v84, v85
    v_add_f32 v86, v86, v87
    v_add_f32 v84, v84, v86
    s_mov_b32 exec_hi, 0
    ds_write_b32 v29, v84 offset:1792
    s_mov_b64 exec, -1
    s_waitcnt vmcnt(0)
    s_lshl_b32 s50, s43, 2
    s_add_u32 s50, s50, s41
    s_lshl_b32 s50, s50, 5
    s_add_u32 s50, s50, s42
    s_lshl_b32 s50, s50, 2
    s_add_u32 s50, s50, 20480
    s_mov_b64 exec, 1
    buffer_store_dword v17, v16, s[28:31], s50 offen sc1
    s_mov_b64 exec, -1
    v_and_b32 v5, 2, v0
    v_and_b32 v6, 1, v9
    v_xor_b32 v5, v5, v6
    v_lshlrev_b32 v5, 4, v5
    v_and_b32 v6, 1, v0
    v_lshl_add_u32 v5, v6, 3, v5
    v_add_u32 v5, v5, v10
    v_lshl_add_u32 v50, v9, 10, v5
    v_add_u32 v50, 151552, v50
    v_xor_b32 v51, 16, v50
    v_lshl_add_u32 v52, v13, 7, v14
    v_xor_b32 v53, 16, v52
    v_lshl_add_u32 v54, v13, 12, v14
    v_add_u32 v55, 31744, v54
    s_sub_u32 s50, 512, s76
    s_cmp_eq_u32 s76, 256
    s_cselect_b32 s50, 0, s50
    s_cselect_b32 s51, 0, -1
    s_cmp_eq_u32 s48, 0
    s_cselect_b32 s81, s76, s50
    s_cselect_b32 s89, -1, s51
    s_movk_i32 s50, 80
    v_mul_u32_u24 v1, s50, v8
    v_lshl_add_u32 v1, v9, 3, v1
    s_mul_i32 s51, s48, 5120
    s_add_u32 s51, s51, 151552
    s_lshl_b32 s52, s47, 5
    s_add_u32 s52, s52, s51
    v_add_u32 v48, s52, v1
    v_lshrrev_b32 v2, 2, v0
    v_mul_u32_u24 v2, s50, v2
    v_and_b32 v3, 3, v0
    v_lshl_add_u32 v2, v3, 4, v2
    s_mul_i32 s52, s47, 2560
    s_add_u32 s52, s52, s51
    v_add_u32 v49, s52, v2
    s_lshl_b32 s90, s43, 2
    s_lshr_b32 s50, s42, 3
    s_add_u32 s90, s90, s50
    s_lshl_b32 s90, s90, 7
    s_lshl_b32 s50, s47, 6
    s_add_u32 s90, s90, s50
    s_add_u32 s90, s90, 20480
    s_lshl_b32 s88, s47, 4
    v_add_u32 v30, s88, v8
    v_lshrrev_b32 v31, 1, v9
    v_and_b32 v38, 1, v9
    v_cvt_f32_u32 v30, v30
    v_lshlrev_b32 v31, 4, v31
    v_lshl_add_u32 v31, v38, 2, v31
    s_mul_i32 s88, s48, 0x80008000
    v_cvt_f32_u32 v31, v31
    v_mul_f32 v38, 0x3a000000, v30
    v_mul_f32 v30, 0x3d000000, v30
    v_mul_f32 v39, v31, v38
    v_fmamk_f32 v60, v38, 0x0, v39
    v_fmamk_f32 v61, v38, 0x3f800000, v39
    v_fmamk_f32 v62, v38, 0x40000000, v39
    v_fmamk_f32 v63, v38, 0x40400000, v39
    v_fmamk_f32 v64, v38, 0x41000000, v39
    v_fmamk_f32 v65, v38, 0x41100000, v39
    v_fmamk_f32 v66, v38, 0x41200000, v39
    v_fmamk_f32 v67, v38, 0x41300000, v39
    v_cos_f32 v176, v60
    v_sin_f32 v192, v60
    v_cos_f32 v177, v61
    v_sin_f32 v193, v61
    v_cos_f32 v178, v62
    v_sin_f32 v194, v62
    v_cos_f32 v179, v63
    v_sin_f32 v195, v63
    v_cos_f32 v180, v64
    v_sin_f32 v196, v64
    v_cos_f32 v181, v65
    v_sin_f32 v197, v65
    v_cos_f32 v182, v66
    v_sin_f32 v198, v66
    v_cos_f32 v183, v67
    v_sin_f32 v199, v67
    v_fmamk_f32 v60, v38, 0x42000000, v39
    v_fmamk_f32 v61, v38, 0x42040000, v39
    v_fmamk_f32 v62, v38, 0x42080000, v39
    v_fmamk_f32 v63, v38, 0x420c0000, v39
    v_fmamk_f32 v64, v38, 0x42200000, v39
    v_fmamk_f32 v65, v38, 0x42240000, v39
    v_fmamk_f32 v66, v38, 0x42280000, v39
    v_fmamk_f32 v67, v38, 0x422c0000, v39
    v_cos_f32 v184, v60
    v_sin_f32 v200, v60
    v_cos_f32 v185, v61
    v_sin_f32 v201, v61
    v_cos_f32 v186, v62
    v_sin_f32 v202, v62
    v_cos_f32 v187, v63
    v_sin_f32 v203, v63
    v_cos_f32 v188, v64
    v_sin_f32 v204, v64
    v_cos_f32 v189, v65
    v_sin_f32 v205, v65
    v_cos_f32 v190, v66
    v_sin_f32 v206, v66
    v_cos_f32 v191, v67
    v_sin_f32 v207, v67
    v_lshlrev_b32 v39, 3, v9
    v_cvt_f32_u32 v38, v8
    v_cvt_f32_u32 v39, v39
    v_mul_f32 v38, 0x3c800000, v38
    v_mul_f32 v39, v39, v30
    v_mul_f32 v31, v31, v38
    v_fmamk_f32 v60, v30, 0x0, v39
    v_fmamk_f32 v61, v30, 0x3f800000, v39
    v_fmamk_f32 v62, v30, 0x40000000, v39
    v_fmamk_f32 v63, v30, 0x40400000, v39
    v_fmamk_f32 v64, v30, 0x40800000, v39
    v_fmamk_f32 v65, v30, 0x40a00000, v39
    v_fmamk_f32 v66, v30, 0x40c00000, v39
    v_fmamk_f32 v67, v30, 0x40e00000, v39
    v_cos_f32 v68, v60
    v_sin_f32 v76, v60
    v_cos_f32 v69, v61
    v_sin_f32 v77, v61
    v_cos_f32 v70, v62
    v_sin_f32 v78, v62
    s_waitcnt lgkmcnt(0)
    s_barrier
    v_cos_f32 v71, v63
    v_sin_f32 v79, v63
    v_cos_f32 v72, v64
    v_sin_f32 v80, v64
    v_cos_f32 v73, v65
    v_sin_f32 v81, v65
    v_cos_f32 v74, v66
    v_sin_f32 v82, v66
    v_cos_f32 v75, v67
    s_mul_i32 s50, s48, 16384
    s_mul_i32 s51, s47, 8192
    s_add_u32 s50, s50, s51
    s_add_u32 m0, s50, 32768
    s_lshl_b32 s51, s51, 3
    s_add_u32 s86, s84, s51
    s_add_u32 s86, s86, 0
    buffer_load_dwordx4 v40, s[20:23], s86 offen offset:0 lds
    v_sin_f32 v83, v67
    v_fmamk_f32 v60, v38, 0x0, v31
    v_fmamk_f32 v61, v38, 0x3f800000, v31
    v_fmamk_f32 v62, v38, 0x40000000, v31
    v_fmamk_f32 v63, v38, 0x40400000, v31
    v_fmamk_f32 v64, v38, 0x41000000, v31
    v_fmamk_f32 v65, v38, 0x41100000, v31
    v_fmamk_f32 v66, v38, 0x41200000, v31
    buffer_load_dwordx4 v41, s[20:23], s86 offen offset:1024 lds
    v_fmamk_f32 v67, v38, 0x41300000, v31
    v_cvt_pk_bf16_f32 v240, v68, v69
    v_cvt_pk_bf16_f32 v241, v70, v71
    v_cvt_pk_bf16_f32 v242, v72, v73
    v_cvt_pk_bf16_f32 v243, v74, v75
    v_cvt_pk_bf16_f32 v252, v76, v77
    v_cvt_pk_bf16_f32 v253, v78, v79
    v_cvt_pk_bf16_f32 v254, v80, v81
    v_cvt_pk_bf16_f32 v255, v82, v83
    buffer_load_dwordx4 v42, s[20:23], s86 offen offset:2048 lds
    v_xor_b32 v248, s88, v240
    v_xor_b32 v249, s88, v241
    v_xor_b32 v250, s88, v242
    v_xor_b32 v251, s88, v243
    v_xor_b32 v244, s88, v252
    v_xor_b32 v245, s88, v253
    v_xor_b32 v246, s88, v254
    v_xor_b32 v247, s88, v255
    buffer_load_dwordx4 v43, s[20:23], s86 offen offset:3072 lds
    v_xor_b32 v252, 0x80008000, v252
    v_xor_b32 v253, 0x80008000, v253
    v_xor_b32 v254, 0x80008000, v254
    v_xor_b32 v255, 0x80008000, v255
    v_cos_f32 v68, v60
    v_sin_f32 v76, v60
    v_cos_f32 v69, v61
    v_sin_f32 v77, v61
    v_cos_f32 v70, v62
    s_add_u32 m0, m0, 4096
    s_add_u32 s86, s86, 32768
    buffer_load_dwordx4 v40, s[20:23], s86 offen offset:0 lds
    v_sin_f32 v78, v62
    v_cos_f32 v71, v63
    v_sin_f32 v79, v63
    v_cos_f32 v72, v64
    v_sin_f32 v80, v64
    v_cos_f32 v73, v65
    v_sin_f32 v81, v65
    v_cos_f32 v74, v66
    buffer_load_dwordx4 v41, s[20:23], s86 offen offset:1024 lds
    v_sin_f32 v82, v66
    v_cos_f32 v75, v67
    v_sin_f32 v83, v67
    v_fmamk_f32 v60, v38, 0x42000000, v31
    v_fmamk_f32 v61, v38, 0x42040000, v31
    v_fmamk_f32 v62, v38, 0x42080000, v31
    v_fmamk_f32 v63, v38, 0x420c0000, v31
    v_fmamk_f32 v64, v38, 0x42200000, v31
    v_fmamk_f32 v65, v38, 0x42240000, v31
    buffer_load_dwordx4 v42, s[20:23], s86 offen offset:2048 lds
    v_fmamk_f32 v66, v38, 0x42280000, v31
    v_fmamk_f32 v67, v38, 0x422c0000, v31
    v_cvt_pk_bf16_f32 v208, v68, v69
    v_cvt_pk_bf16_f32 v209, v70, v71
    v_cvt_pk_bf16_f32 v210, v76, v77
    v_cvt_pk_bf16_f32 v211, v78, v79
    v_cvt_pk_bf16_f32 v212, v68, -v77
    v_cvt_pk_bf16_f32 v213, -v70, v79
    buffer_load_dwordx4 v43, s[20:23], s86 offen offset:3072 lds
    v_cvt_pk_bf16_f32 v214, v76, v69
    v_cvt_pk_bf16_f32 v215, -v78, -v71
    v_cvt_pk_bf16_f32 v216, v72, v73
    v_cvt_pk_bf16_f32 v217, v74, v75
    v_cvt_pk_bf16_f32 v218, v80, v81
    v_cvt_pk_bf16_f32 v219, v82, v83
    v_cvt_pk_bf16_f32 v220, v72, -v81
    v_cvt_pk_bf16_f32 v221, -v74, v83
    v_cvt_pk_bf16_f32 v222, v80, v73
    s_mul_i32 s50, s48, 10240
    s_mul_i32 s51, s47, 5120
    s_add_u32 s50, s50, s51
    s_add_u32 m0, s50, 131072
    s_lshl_b32 s51, s51, 3
    s_add_u32 s86, s84, s51
    s_add_u32 s86, s86, 131072
    buffer_load_dwordx4 v40, s[20:23], s86 offen offset:0 lds
    v_cvt_pk_bf16_f32 v223, -v82, -v75
    v_cos_f32 v68, v60
    v_sin_f32 v76, v60
    v_cos_f32 v69, v61
    v_sin_f32 v77, v61
    v_cos_f32 v70, v62
    v_sin_f32 v78, v62
    v_cos_f32 v71, v63
    buffer_load_dwordx4 v41, s[20:23], s86 offen offset:1024 lds
    v_sin_f32 v79, v63
    v_cos_f32 v72, v64
    v_sin_f32 v80, v64
    v_cos_f32 v73, v65
    v_sin_f32 v81, v65
    v_cos_f32 v74, v66
    v_sin_f32 v82, v66
    v_cos_f32 v75, v67
    v_sin_f32 v83, v67
    buffer_load_dwordx4 v42, s[20:23], s86 offen offset:2048 lds
    v_cvt_pk_bf16_f32 v224, v68, v69
    v_cvt_pk_bf16_f32 v225, v70, v71
    v_cvt_pk_bf16_f32 v226, v76, v77
    v_cvt_pk_bf16_f32 v227, v78, v79
    v_cvt_pk_bf16_f32 v228, v68, -v77
    v_cvt_pk_bf16_f32 v229, -v70, v79
    v_cvt_pk_bf16_f32 v230, v76, v69
    v_cvt_pk_bf16_f32 v231, -v78, -v71
    buffer_load_dwordx4 v43, s[20:23], s86 offen offset:3072 lds
    v_cvt_pk_bf16_f32 v232, v72, v73
    v_cvt_pk_bf16_f32 v233, v74, v75
    v_cvt_pk_bf16_f32 v234, v80, v81
    v_cvt_pk_bf16_f32 v235, v82, v83
    v_cvt_pk_bf16_f32 v236, v72, -v81
    v_cvt_pk_bf16_f32 v237, -v74, v83
    v_cvt_pk_bf16_f32 v238, v80, v73
    v_cvt_pk_bf16_f32 v239, -v82, -v75
    s_add_u32 m0, m0, 4096
    s_add_u32 s86, s86, 32768
    buffer_load_dwordx4 v40, s[20:23], s86 offen offset:0 lds
    s_barrier
    s_mul_i32 s50, s48, 32768
    s_mul_i32 s51, s47, 16384
    s_add_u32 s50, s50, s51
    s_add_u32 m0, s50, 65536
    s_lshl_b32 s51, s51, 3
    s_add_u32 s86, s84, s51
    s_add_u32 s86, s86, 212992
    buffer_load_dwordx4 v40, s[20:23], s86 offen offset:0 lds
    buffer_load_dwordx4 v41, s[20:23], s86 offen offset:1024 lds
    buffer_load_dwordx4 v42, s[20:23], s86 offen offset:2048 lds
    buffer_load_dwordx4 v43, s[20:23], s86 offen offset:3072 lds
    s_add_u32 m0, m0, 4096
    s_add_u32 s86, s86, 32768
    buffer_load_dwordx4 v40, s[20:23], s86 offen offset:0 lds
    buffer_load_dwordx4 v41, s[20:23], s86 offen offset:1024 lds
    buffer_load_dwordx4 v42, s[20:23], s86 offen offset:2048 lds
    buffer_load_dwordx4 v43, s[20:23], s86 offen offset:3072 lds
    s_mov_b32 s57, 60000
L_poll_1001:
    s_load_dwordx16 s[60:75], s[28:29], s90 glc
    s_waitcnt lgkmcnt(0)
    s_xor_b64 s[60:61], s[60:61], s[58:59]
    s_xor_b64 s[62:63], s[62:63], s[58:59]
    s_xor_b64 s[64:65], s[64:65], s[58:59]
    s_xor_b64 s[66:67], s[66:67], s[58:59]
    s_xor_b64 s[68:69], s[68:69], s[58:59]
    s_xor_b64 s[70:71], s[70:71], s[58:59]
    s_xor_b64 s[72:73], s[72:73], s[58:59]
    s_xor_b64 s[74:75], s[74:75], s[58:59]
    s_or_b64 s[60:61], s[60:61], s[68:69]
    s_or_b64 s[62:63], s[62:63], s[70:71]
    s_or_b64 s[64:65], s[64:65], s[72:73]
    s_or_b64 s[66:67], s[66:67], s[74:75]
    s_or_b64 s[60:61], s[60:61], s[64:65]
    s_or_b64 s[62:63], s[62:63], s[66:67]
    s_or_b64 s[60:61], s[60:61], s[62:63]
    s_cbranch_scc0 L_pdone_1002
    s_sub_u32 s57, s57, 1
    s_cbranch_scc0 L_poll_1001
L_pdone_1002:
    s_mov_b32 s80, m0
    s_lshl_b32 s50, s41, 11
    s_add_u32 m0, s50, 151552
    s_sub_u32 s51, s76, 1
    s_lshl_b32 s51, s51, 13
    s_add_u32 s51, s51, s50
    s_add_u32 s51, s51, 11534336
    buffer_load_dwordx4 v52, s[28:31], s51 offen sc1 lds
    buffer_load_dwordx4 v53, s[28:31], s51 offen offset:1024 sc1 lds
    s_mov_b32 m0, s80
    s_add_u32 m0, m0, 4096
    s_add_u32 s86, s86, 32768
    buffer_load_dwordx4 v40, s[20:23], s86 offen offset:0 lds
    buffer_load_dwordx4 v41, s[20:23], s86 offen offset:1024 lds
    buffer_load_dwordx4 v42, s[20:23], s86 offen offset:2048 lds
    buffer_load_dwordx4 v43, s[20:23], s86 offen offset:3072 lds
    s_add_u32 m0, m0, 4096
    s_add_u32 s86, s86, 32768
    buffer_load_dwordx4 v40, s[20:23], s86 offen offset:0 lds
    buffer_load_dwordx4 v41, s[20:23], s86 offen offset:1024 lds
    buffer_load_dwordx4 v42, s[20:23], s86 offen offset:2048 lds
    buffer_load_dwordx4 v43, s[20:23], s86 offen offset:3072 lds
    s_lshr_b32 s90, s42, 4
    s_lshl_b32 s90, s90, 11
    s_lshl_b32 s50, s43, 8
    s_add_u32 s90, s90, s50
    s_lshl_b32 s50, s41, 6
    s_add_u32 s90, s90, s50
    s_add_u32 s90, s90, 24576
    s_lshl_b32 s91, s43, 18
    s_lshl_b32 s51, s41, 16
    s_add_u32 s91, s91, s51
    s_lshl_b32 s51, s42, 7
    s_add_u32 s91, s91, s51
    s_add_u32 s91, s91, 13631488
    s_lshl_b32 s53, s81, 12
    s_lshl_b32 s51, s47, 11
    s_add_u32 s53, s53, s51
    s_add_u32 s53, s53, 13631488
    s_lshl_b32 s50, s48, 14
    v_add_u32 v2, s50, v7
    s_mul_i32 s50, s47, 3072
    v_add_u32 v3, s50, v2
    s_mul_i32 s50, s47, 5120
    v_add_u32 v5, s50, v2
    s_mul_i32 s50, s47, 6144
    v_add_u32 v4, s50, v2
    s_waitcnt vmcnt(8) lgkmcnt(0)
    s_barrier
    ds_read_b64_tr_b16 v[28:29], v50 offset:0
    ds_read_b64_tr_b16 v[30:31], v50 offset:512
    ds_read_b64_tr_b16 v[64:65], v50 offset:4096
    ds_read_b64_tr_b16 v[66:67], v50 offset:4608
    ds_read_b64_tr_b16 v[32:33], v51 offset:0
    ds_read_b64_tr_b16 v[34:35], v51 offset:512
    ds_read_b64_tr_b16 v[68:69], v51 offset:4096
    ds_read_b64_tr_b16 v[70:71], v51 offset:4608
    ds_read_b64_tr_b16 v[56:57], v50 offset:256
    ds_read_b64_tr_b16 v[58:59], v50 offset:768
    ds_read_b64_tr_b16 v[72:73], v50 offset:4352
    ds_read_b64_tr_b16 v[74:75], v50 offset:4864
    ds_read_b64_tr_b16 v[60:61], v51 offset:256
    ds_read_b64_tr_b16 v[62:63], v51 offset:768
    ds_read_b64_tr_b16 v[76:77], v51 offset:4352
    s_waitcnt lgkmcnt(14)
    ds_read_b64_tr_b16 v[78:79], v51 offset:4864
    s_mul_i32 s50, s48, 16384
    s_mul_i32 s51, s47, 3072
    s_add_u32 s50, s50, s51
    s_add_u32 m0, s50, 0
    s_lshl_b32 s51, s51, 3
    s_add_u32 s86, s84, s51
    s_add_u32 s86, s86, 475136
    buffer_load_dwordx4 v40, s[20:23], s86 offen offset:0 lds
    buffer_load_dwordx4 v41, s[20:23], s86 offen offset:1024 lds
    buffer_load_dwordx4 v42, s[20:23], s86 offen offset:2048 lds
    s_waitcnt lgkmcnt(12)
    v_mfma_f32_16x16x32_bf16 v[80:83], v[28:31], v[240:243], 0
    v_mfma_f32_16x16x32_bf16 v[84:87], v[64:67], v[248:251], 0
    v_mfma_f32_16x16x32_bf16 v[80:83], v[64:67], v[244:247], v[80:83]
    v_mfma_f32_16x16x32_bf16 v[84:87], v[28:31], v[252:255], v[84:87]
    s_waitcnt lgkmcnt(8)
    v_mfma_f32_16x16x32_bf16 v[88:91], v[32:35], v[240:243], 0
    v_mfma_f32_16x16x32_bf16 v[92:95], v[68:71], v[248:251], 0
    v_mfma_f32_16x16x32_bf16 v[88:91], v[68:71], v[244:247], v[88:91]
    v_mfma_f32_16x16x32_bf16 v[92:95], v[32:35], v[252:255], v[92:95]
    s_waitcnt lgkmcnt(4)
    v_mfma_f32_16x16x32_bf16 v[96:99], v[56:59], v[240:243], 0
    v_mfma_f32_16x16x32_bf16 v[100:103], v[72:75], v[248:251], 0
    v_mfma_f32_16x16x32_bf16 v[96:99], v[72:75], v[244:247], v[96:99]
    v_mfma_f32_16x16x32_bf16 v[100:103], v[56:59], v[252:255], v[100:103]
    s_waitcnt lgkmcnt(0)
    v_mfma_f32_16x16x32_bf16 v[104:107], v[60:63], v[240:243], 0
    v_mfma_f32_16x16x32_bf16 v[108:111], v[76:79], v[248:251], 0
    v_mfma_f32_16x16x32_bf16 v[104:107], v[76:79], v[244:247], v[104:107]
    v_mfma_f32_16x16x32_bf16 v[108:111], v[60:63], v[252:255], v[108:111]
    s_mov_b64 exec, 1
    ds_add_u32 v36, v37
    s_mov_b64 exec, -1
    s_mul_i32 s50, s48, 16384
    s_mul_i32 s51, s47, 5120
    s_add_u32 s50, s50, s51
    s_add_u32 m0, s50, 6144
    s_lshl_b32 s51, s51, 3
    s_add_u32 s86, s85, s51
    s_add_u32 s86, s86, 524288
    buffer_load_dwordx4 v40, s[20:23], s86 offen offset:0 lds
    buffer_load_dwordx4 v41, s[20:23], s86 offen offset:1024 lds
    buffer_load_dwordx4 v42, s[20:23], s86 offen offset:2048 lds
    buffer_load_dwordx4 v43, s[20:23], s86 offen offset:3072 lds
    s_add_u32 m0, m0, 4096
    s_add_u32 s86, s86, 32768
    buffer_load_dwordx4 v40, s[20:23], s86 offen offset:0 lds
    v_pk_mul_f32 v[18:19], v[80:81], v[176:177]
    v_pk_mul_f32 v[44:45], v[82:83], v[178:179]
    v_pk_mul_f32 v[38:39], v[84:85], v[176:177]
    v_pk_mul_f32 v[46:47], v[86:87], v[178:179]
    v_pk_fma_f32 v[18:19], v[84:85], v[192:193], v[18:19]
    v_pk_fma_f32 v[44:45], v[86:87], v[194:195], v[44:45]
    v_pk_fma_f32 v[38:39], v[80:81], v[192:193], v[38:39] neg_lo:[0,1,0] neg_hi:[0,1,0]
    v_pk_fma_f32 v[46:47], v[82:83], v[194:195], v[46:47] neg_lo:[0,1,0] neg_hi:[0,1,0]
    v_cvt_pk_bf16_f32 v28, v18, v19
    v_cvt_pk_bf16_f32 v29, v44, v45
    v_cvt_pk_bf16_f32 v30, v38, v39
    v_cvt_pk_bf16_f32 v31, v46, v47
    v_pk_mul_f32 v[18:19], v[88:89], v[180:181]
    v_pk_mul_f32 v[44:45], v[90:91], v[182:183]
    v_pk_mul_f32 v[38:39], v[92:93], v[180:181]
    v_pk_mul_f32 v[46:47], v[94:95], v[182:183]
    v_pk_fma_f32 v[18:19], v[92:93], v[196:197], v[18:19]
    v_pk_fma_f32 v[44:45], v[94:95], v[198:199], v[44:45]
    v_pk_fma_f32 v[38:39], v[88:89], v[196:197], v[38:39] neg_lo:[0,1,0] neg_hi:[0,1,0]
    v_pk_fma_f32 v[46:47], v[90:91], v[198:199], v[46:47] neg_lo:[0,1,0] neg_hi:[0,1,0]
    v_cvt_pk_bf16_f32 v32, v18, v19
    v_cvt_pk_bf16_f32 v33, v44, v45
    v_cvt_pk_bf16_f32 v34, v38, v39
    v_cvt_pk_bf16_f32 v35, v46, v47
    v_pk_mul_f32 v[18:19], v[96:97], v[184:185]
    v_pk_mul_f32 v[44:45], v[98:99], v[186:187]
    v_pk_mul_f32 v[38:39], v[100:101], v[184:185]
    v_pk_mul_f32 v[46:47], v[102:103], v[186:187]
    v_pk_fma_f32 v[18:19], v[100:101], v[200:201], v[18:19]
    v_pk_fma_f32 v[44:45], v[102:103], v[202:203], v[44:45]
    v_pk_fma_f32 v[38:39], v[96:97], v[200:201], v[38:39] neg_lo:[0,1,0] neg_hi:[0,1,0]
    v_pk_fma_f32 v[46:47], v[98:99], v[202:203], v[46:47] neg_lo:[0,1,0] neg_hi:[0,1,0]
    v_cvt_pk_bf16_f32 v56, v18, v19
    v_cvt_pk_bf16_f32 v57, v44, v45
    v_cvt_pk_bf16_f32 v58, v38, v39
    v_cvt_pk_bf16_f32 v59, v46, v47
    v_pk_mul_f32 v[18:19], v[104:105], v[188:189]
    v_pk_mul_f32 v[44:45], v[106:107], v[190:191]
    v_pk_mul_f32 v[38:39], v[108:109], v[188:189]
    v_pk_mul_f32 v[46:47], v[110:111], v[190:191]
    v_pk_fma_f32 v[18:19], v[108:109], v[204:205], v[18:19]
    v_pk_fma_f32 v[44:45], v[110:111], v[206:207], v[44:45]
    v_pk_fma_f32 v[38:39], v[104:105], v[204:205], v[38:39] neg_lo:[0,1,0] neg_hi:[0,1,0]
    v_pk_fma_f32 v[46:47], v[106:107], v[206:207], v[46:47] neg_lo:[0,1,0] neg_hi:[0,1,0]
    v_cvt_pk_bf16_f32 v60, v18, v19
    v_cvt_pk_bf16_f32 v61, v44, v45
    v_cvt_pk_bf16_f32 v62, v38, v39
    v_cvt_pk_bf16_f32 v63, v46, v47
    v_mfma_f32_16x16x32_bf16 v[80:83], v[28:31], v[208:211], 0
    v_xor_b32 v64, 0x80000000, v28
    v_xor_b32 v65, 0x80000000, v29
    v_mfma_f32_16x16x32_bf16 v[80:83], v[32:35], v[216:219], v[80:83]
    v_xor_b32 v66, 0x80000000, v30
    v_xor_b32 v67, 0x80000000, v31
    v_mfma_f32_16x16x32_bf16 v[80:83], v[56:59], v[224:227], v[80:83]
    v_xor_b32 v68, 0x80000000, v32
    v_xor_b32 v69, 0x80000000, v33
    v_mfma_f32_16x16x32_bf16 v[80:83], v[60:63], v[232:235], v[80:83]
    v_xor_b32 v70, 0x80000000, v34
    v_xor_b32 v71, 0x80000000, v35
    v_mfma_f32_16x16x32_bf16 v[84:87], v[28:31], v[212:215], 0
    v_xor_b32 v72, 0x80000000, v56
    v_xor_b32 v73, 0x80000000, v57
    v_mfma_f32_16x16x32_bf16 v[84:87], v[32:35], v[220:223], v[84:87]
    v_xor_b32 v74, 0x80000000, v58
    v_xor_b32 v75, 0x80000000, v59
    v_mfma_f32_16x16x32_bf16 v[84:87], v[56:59], v[228:231], v[84:87]
    v_xor_b32 v76, 0x80000000, v60
    v_xor_b32 v77, 0x80000000, v61
    v_mfma_f32_16x16x32_bf16 v[84:87], v[60:63], v[236:239], v[84:87]
    v_xor_b32 v78, 0x80000000, v62
    v_xor_b32 v79, 0x80000000, v63
    v_mfma_f32_16x16x32_bf16 v[88:91], v[64:67], v[208:211], 0
    v_mfma_f32_16x16x32_bf16 v[88:91], v[68:71], v[216:219], v[88:91]
    v_mfma_f32_16x16x32_bf16 v[88:91], v[72:75], v[224:227], v[88:91]
    v_mfma_f32_16x16x32_bf16 v[88:91], v[76:79], v[232:235], v[88:91]
    v_mfma_f32_16x16x32_bf16 v[92:95], v[64:67], v[212:215], 0
    v_mfma_f32_16x16x32_bf16 v[92:95], v[68:71], v[220:223], v[92:95]
    v_mfma_f32_16x16x32_bf16 v[92:95], v[72:75], v[228:231], v[92:95]
    v_mfma_f32_16x16x32_bf16 v[92:95], v[76:79], v[236:239], v[92:95]
    v_cvt_pk_bf16_f32 v20, v80, v81
    v_cvt_pk_bf16_f32 v21, v82, v83
    v_cvt_pk_bf16_f32 v22, v84, v85
    v_cvt_pk_bf16_f32 v23, v86, v87
    v_cvt_pk_bf16_f32 v24, v88, v89
    v_cvt_pk_bf16_f32 v25, v90, v91
    s_nop 1
    v_cvt_pk_bf16_f32 v26, v92, v93
    v_cvt_pk_bf16_f32 v27, v94, v95
    v_and_b32 v20, s89, v20
    v_and_b32 v21, s89, v21
    v_and_b32 v22, s89, v22
    v_and_b32 v23, s89, v23
    v_and_b32 v24, s89, v24
    v_and_b32 v25, s89, v25
    v_and_b32 v26, s89, v26
    v_and_b32 v27, s89, v27
    s_mov_b32 s57, 60000
L_cnt_1003:
    ds_read_b32 v1, v36
    s_waitcnt lgkmcnt(0)
    v_cmp_gt_u32 vcc, 8, v1
    s_cbranch_vccz L_cntd_1004
    s_sub_u32 s57, s57, 1
    s_cbranch_scc0 L_cnt_1003
L_cntd_1004:
    ds_write_b64 v48, v[20:21] offset:0
    ds_write_b64 v48, v[22:23] offset:1280
    ds_write_b64 v48, v[24:25] offset:2560
    ds_write_b64 v48, v[26:27] offset:3840
    s_waitcnt lgkmcnt(0)
    s_barrier
    ds_read_b128 v[20:23], v49
    ds_read_b128 v[24:27], v49 offset:1280
    s_waitcnt lgkmcnt(0)
    buffer_store_dwordx4 v[20:23], v7, s[28:31], s53 offen sc1
    buffer_store_dwordx4 v[24:27], v7, s[28:31], s53 offen offset:1024 sc1
    s_mul_i32 s50, s48, 16384
    s_mul_i32 s51, s47, 6144
    s_add_u32 s50, s50, s51
    s_add_u32 m0, s50, 32768
    s_lshl_b32 s51, s51, 3
    s_add_u32 s86, s85, s51
    s_add_u32 s86, s86, 606208
    buffer_load_dwordx4 v40, s[20:23], s86 offen offset:0 lds
    buffer_load_dwordx4 v41, s[20:23], s86 offen offset:1024 lds
    buffer_load_dwordx4 v42, s[20:23], s86 offen offset:2048 lds
    buffer_load_dwordx4 v43, s[20:23], s86 offen offset:3072 lds
    s_add_u32 m0, m0, 4096
    s_add_u32 s86, s86, 32768
    buffer_load_dwordx4 v40, s[20:23], s86 offen offset:0 lds
    buffer_load_dwordx4 v41, s[20:23], s86 offen offset:1024 lds
    s_waitcnt vmcnt(6) lgkmcnt(0)
    s_lshl_b32 s50, s47, 9
    s_add_u32 s50, s50, s81
    s_lshl_b32 s50, s50, 2
    s_add_u32 s50, s50, 24576
    s_mov_b64 exec, 1
    buffer_store_dword v17, v16, s[28:31], s50 offen sc1
    s_mov_b64 exec, -1
    s_barrier
    s_lshl_b32 s51, s41, 11
    s_add_u32 m0, s51, 151552
    s_waitcnt vmcnt(1)
    s_barrier
    s_mov_b32 s57, 60000
L_poll_1005:
    s_load_dwordx16 s[60:75], s[28:29], s90 glc
    s_waitcnt lgkmcnt(0)
    s_xor_b64 s[60:61], s[60:61], s[58:59]
    s_xor_b64 s[62:63], s[62:63], s[58:59]
    s_xor_b64 s[64:65], s[64:65], s[58:59]
    s_xor_b64 s[66:67], s[66:67], s[58:59]
    s_xor_b64 s[68:69], s[68:69], s[58:59]
    s_xor_b64 s[70:71], s[70:71], s[58:59]
    s_xor_b64 s[72:73], s[72:73], s[58:59]
    s_xor_b64 s[74:75], s[74:75], s[58:59]
    s_or_b64 s[60:61], s[60:61], s[68:69]
    s_or_b64 s[62:63], s[62:63], s[70:71]
    s_or_b64 s[64:65], s[64:65], s[72:73]
    s_or_b64 s[66:67], s[66:67], s[74:75]
    s_or_b64 s[60:61], s[60:61], s[64:65]
    s_or_b64 s[62:63], s[62:63], s[66:67]
    s_or_b64 s[60:61], s[60:61], s[62:63]
    s_cbranch_scc0 L_pdone_1006
    s_sub_u32 s57, s57, 1
    s_cbranch_scc0 L_poll_1005
L_pdone_1006:
    buffer_load_dwordx4 v54, s[28:31], s91 offen sc1 lds
    buffer_load_dwordx4 v55, s[28:31], s91 offen offset:1024 sc1 lds
    s_waitcnt vmcnt(0)
    s_barrier
    s_add_u32 s50, s2, s41
    s_cmp_lg_u32 s50, 0
    s_cbranch_scc1 L_noepoch_1007
    v_lshrrev_b32 v1, 5, v0
    v_lshlrev_b32 v1, 9, v1
    v_and_b32 v2, 31, v0
    v_lshl_add_u32 v1, v2, 2, v1
    s_mov_b32 s51, 20480
    s_mov_b32 s57, 60000
L_ep_1008:
    buffer_load_dword v3, v1, s[28:31], s51 offen offset:0 sc1
    buffer_load_dword v4, v1, s[28:31], s51 offen offset:1024 sc1
    buffer_load_dword v5, v1, s[28:31], s51 offen offset:2048 sc1
    buffer_load_dword v6, v1, s[28:31], s51 offen offset:3072 sc1
    s_waitcnt vmcnt(0)
    v_xor_b32 v3, s58, v3
    v_xor_b32 v4, s58, v4
    v_xor_b32 v5, s58, v5
    v_xor_b32 v6, s58, v6
    v_or_b32 v3, v3, v4
    v_or3_b32 v3, v3, v5, v6
    v_cmp_ne_u32 vcc, 0, v3
    s_cbranch_vccz L_epd_1009
    s_sub_u32 s57, s57, 1
    s_cbranch_scc0 L_ep_1008
L_epd_1009:
    s_mov_b64 exec, 1
    buffer_store_dword v17, v16, s[28:31], 0 offen offset:0 sc1
    s_mov_b64 exec, -1
L_noepoch_1007:
    s_endpgm
L_compute:
    s_load_dwordx4 s[36:39], s[0:1], 24
    s_mov_b32 s10, 524288
    s_mov_b32 s11, 0x20000
    s_mov_b32 s26, 524288
    s_mov_b32 s27, 0x20000
    v_lshlrev_b32 v1, 7, v0
    s_lshl_b32 s50, s42, 3
    s_add_u32 s50, s50, s43
    s_lshl_b32 s50, s50, 2
    s_add_u32 s50, s50, s41
    s_lshl_b32 s52, s50, 11
    s_waitcnt lgkmcnt(0)
    s_bitcmp1_b32 s41, 0
    s_cselect_b32 s24, s38, s36
    s_cselect_b32 s25, s39, s37
    s_lshl_b32 s51, s50, 9
    s_mov_b64 exec, 15
    buffer_load_dword v251, v1, s[8:11], s51 offen
    s_lshr_b32 s51, s50, 2
    s_add_u32 s51, s51, 1
    s_lshl_b32 s51, s51, 10
    s_lshr_b32 s50, s41, 1
    s_lshl_b32 s50, s50, 7
    s_add_u32 s51, s51, s50
    s_mov_b64 exec, 1
    buffer_load_dword v250, v1, s[24:27], s51 offen
    s_mov_b64 exec, 0xffff
    buffer_load_dword v249, v1, s[4:7], s52 offen
    s_mov_b64 exec, -1
    s_getpc_b64 s[60:61]
L_pc:
    s_sub_u32 s60, s60, L_pc-recurrent_scan__spectral_fnet__mixer_s_mlp__prompt_kernel
    s_subb_u32 s61, s61, 0
    s_mov_b32 s62, L_end-recurrent_scan__spectral_fnet__mixer_s_mlp__prompt_kernel
    s_mov_b32 s63, 0x20000
    s_lshr_b32 s50, s2, 3
    s_lshl_b32 s50, s50, 2
    s_add_u32 s50, s50, s41
    s_mul_i32 s50, s50, 384
    v_lshl_add_u32 v1, v0, 7, s50
    s_mov_b64 exec, 7
    buffer_load_dword v255, v1, s[60:63], 0 offen
    s_mov_b64 exec, -1
    v_and_b32 v8, 15, v0
    v_lshrrev_b32 v9, 4, v0
    v_bfe_u32 v10, v0, 2, 2
    v_lshlrev_b32 v10, 6, v10
    s_and_b32 s47, s41, 1
    s_lshr_b32 s48, s41, 1
    s_lshr_b32 s45, s42, 1
    s_and_b32 s50, s42, 1
    s_lshl_b32 s50, s50, 3
    s_add_u32 s46, s50, s43
    s_lshl_b32 s49, s43, 7
    s_mov_b32 s54, 0x3f803f80
    s_cmp_gt_i32 s44, 0
    s_cselect_b32 s56, 64, -2
    s_add_u32 s56, s56, s47
    s_mov_b32 s34, 2097152
    s_mov_b32 s35, 0x20000
    v_xor_b32 v1, v9, v8
    v_lshlrev_b32 v1, 4, v1
    v_lshl_add_u32 v1, v8, 8, v1
    v_add_u32 v44, s53, v1
    v_xor_b32 v45, 64, v44
    v_xor_b32 v46, 128, v44
    v_xor_b32 v47, 192, v44
    v_add_u32 v3, s55, v8
    v_cmp_lt_u32 vcc, 2047, v3
    v_mov_b32 v60, 0
    v_mov_b32 v61, 0
    s_mov_b64 s[58:59], vcc
    v_mov_b32 v62, 0
    v_mov_b32 v63, 0
    s_lshl_b32 s50, s41, 4
    s_sub_u32 s50, s50, s44
    s_lshl_b32 s50, s50, 2
    s_add_u32 s50, s50, 162064
    v_lshl_add_u32 v11, v8, 2, s50
    s_lshl_b32 s50, s41, 4
    v_add_u32 v1, s50, v8
    s_nop 0
    s_lshr_b32 s50, s43, 1
    s_lshl_b32 s66, s50, 12
    s_lshl_b32 s50, s50, 8
    s_add_u32 s67, s50, 156672
    v_add_u32 v3, s44, v1
    v_and_b32 v4, 1, v3
    v_lshlrev_b32 v4, 10, v4
    v_add_u32 v4, s67, v4
    v_lshrrev_b32 v2, 4, v3
    v_lshlrev_b32 v2, 14, v2
    v_cmp_gt_u32 vcc, 64, v3
    v_and_b32 v3, 15, v3
    v_lshl_add_u32 v2, v3, 8, v2
    v_add_u32 v2, s66, v2
    v_cndmask_b32 v2, v4, v2, vcc
    s_lshl_b32 s50, s48, 2
    s_and_b32 s51, s43, 1
    s_lshl_b32 s51, s51, 3
    s_add_u32 s51, s51, s50
    s_add_u32 s50, s51, s47
    v_and_b32 v5, 2, v9
    v_add_u32 v1, s50, v5
    v_xor_b32 v1, v1, v3
    v_lshl_add_u32 v48, v1, 4, v2
    v_and_b32 v1, 1, v9
    v_lshl_add_u32 v48, v1, 3, v48
    v_xor_b32 v49, 16, v48
    v_xor_b32 v50, 64, v48
    v_xor_b32 v51, 80, v48
    s_lshl_b32 s50, s47, 5
    v_and_b32 v1, 31, v0
    v_add_u32 v1, s50, v1
    v_add_u32 v3, s44, v1
    v_and_b32 v4, 1, v3
    v_lshlrev_b32 v4, 10, v4
    v_add_u32 v4, s67, v4
    v_lshrrev_b32 v2, 4, v3
    v_lshlrev_b32 v2, 14, v2
    v_cmp_gt_u32 vcc, 64, v3
    v_and_b32 v3, 15, v3
    v_lshl_add_u32 v2, v3, 8, v2
    v_add_u32 v2, s66, v2
    v_cndmask_b32 v2, v4, v2, vcc
    v_add_u32 v1, s51, v5
    v_xor_b32 v1, v1, v3
    v_lshl_add_u32 v64, v1, 4, v2
    v_xor_b32 v65, 16, v64
    v_and_b32 v5, 2, v0
    v_and_b32 v6, 1, v9
    v_xor_b32 v5, v5, v6
    v_lshlrev_b32 v5, 4, v5
    v_and_b32 v6, 1, v0
    v_lshl_add_u32 v5, v6, 3, v5
    v_add_u32 v5, v5, v10
    v_lshl_add_u32 v1, v9, 10, v5
    s_lshl_b32 s50, s47, 4
    s_lshl_b32 s51, s48, 8
    s_add_u32 s50, s50, s51
    v_xor_b32 v40, s50, v1
    v_add_u32 v40, 65536, v40
    v_xor_b32 v41, 16, v40
    v_xor_b32 v42, 256, v40
    v_xor_b32 v43, 272, v40
    v_mov_b32 v52, s54
    v_mov_b32 v53, s54
    v_mov_b32 v54, s54
    v_mov_b32 v55, s54
    s_lshl_b32 s50, s41, 6
    s_add_u32 s50, s50, 161792
    v_lshl_add_u32 v56, v9, 4, s50
    v_xor_b32 v57, 64, v56
    v_xor_b32 v58, 128, v56
    v_xor_b32 v59, 192, v56
    v_xor_b32 v1, s47, v9
    v_lshlrev_b32 v1, 10, v1
    s_lshl_b32 s50, s41, 8
    v_lshl_add_u32 v2, v8, 4, s50
    v_add_u32 v17, v1, v2
    v_lshlrev_b32 v15, 2, v0
    s_lshl_b32 s50, s42, 16
    s_lshl_b32 s51, s43, 13
    s_add_u32 s50, s50, s51
    s_lshl_b32 s51, s48, 12
    s_add_u32 s50, s50, s51
    s_add_u32 s60, s50, 1048576
    s_xor_b32 s61, s60, 4096
    s_waitcnt lgkmcnt(0)
    s_load_dword s57, s[28:29], 0
    s_waitcnt lgkmcnt(0)
    s_add_u32 s57, s57, 1
    v_mov_b32 v13, s57
    s_mov_b32 s64, 0
    s_getreg_b32 s50, hwreg(HW_REG_XCC_ID, 0, 4)
    s_lshl_b32 s50, s50, 28
    s_xor_b32 s66, s50, s57
    s_mov_b32 s67, s66
    s_lshl_b32 s68, s45, 7
    s_add_u32 s68, s68, 28672
    s_cmp_lg_u32 s41, 0
    s_cbranch_scc1 L_noxid
    s_lshl_b32 s51, s46, 2
    v_mov_b32 v1, s51
    v_mov_b32 v2, s66
    s_mov_b64 exec, 1
    buffer_store_dword v2, v1, s[28:31], s68 offen sc1
    s_mov_b64 exec, -1
L_noxid:
    s_setprio 2
    v_and_b32 v1, 3, v0
    v_bfe_u32 v2, v0, 2, 2
    v_cmp_eq_u32 s[72:73], 1, v1
    v_cmp_eq_u32 s[74:75], 2, v1
    v_cmp_eq_u32 s[76:77], 3, v1
    v_cmp_eq_u32 s[70:71], v2, v9
    s_lshr_b32 s69, s43, 1
    s_max_u32 s69, s69, 1
    s_barrier
    ds_read_b128 v[192:195], v44 offset:0
    ds_read_b128 v[196:199], v45 offset:0
    ds_read_b128 v[200:203], v46 offset:0
    ds_read_b128 v[204:207], v47 offset:0
    s_cmp_lg_u32 s69, 0
    s_cbranch_scc1 L_res_1
    ds_read_b64 v[68:69], v48
    ds_read_b64 v[70:71], v49
    ds_read_b64 v[72:73], v50
    ds_read_b64 v[74:75], v51
    ds_read_b128 v[20:23], v64
    ds_read_b128 v[24:27], v65
L_res_1:
    ds_read_b64_tr_b16 v[160:161], v40 offset:0
    ds_read_b64_tr_b16 v[162:163], v40 offset:512
    ds_read_b64_tr_b16 v[164:165], v41 offset:0
    ds_read_b64_tr_b16 v[166:167], v41 offset:512
    ds_read_b64_tr_b16 v[168:169], v42 offset:0
    s_waitcnt lgkmcnt(14)
    ds_read_b64_tr_b16 v[170:171], v42 offset:512
    s_waitcnt lgkmcnt(14)
    ds_read_b64_tr_b16 v[172:173], v43 offset:0
    s_waitcnt lgkmcnt(14)
    ds_read_b64_tr_b16 v[174:175], v43 offset:512
    s_waitcnt lgkmcnt(14)
    ds_read_b64_tr_b16 v[176:177], v40 offset:4096
    s_waitcnt lgkmcnt(14)
    ds_read_b64_tr_b16 v[178:179], v40 offset:4608
    s_waitcnt lgkmcnt(14)
    ds_read_b64_tr_b16 v[180:181], v41 offset:4096
    s_waitcnt lgkmcnt(14)
    ds_read_b64_tr_b16 v[182:183], v41 offset:4608
    s_waitcnt lgkmcnt(12)
    ds_read_b64_tr_b16 v[184:185], v42 offset:4096
    ds_read_b64_tr_b16 v[186:187], v42 offset:4608
    s_waitcnt lgkmcnt(10)
    v_mfma_f32_16x16x32_bf16 v[128:131], v[160:163], v[52:55], 0
    v_mfma_f32_16x16x32_bf16 v[144:147], v[160:163], v[192:195], 0
    ds_read_b64_tr_b16 v[188:189], v43 offset:4096
    ds_read_b64_tr_b16 v[190:191], v43 offset:4608
    v_mfma_f32_16x16x32_bf16 v[148:151], v[164:167], v[192:195], 0
    v_mfma_f32_16x16x32_bf16 v[80:83], v[192:195], v[192:195], 0
    ds_read_b64_tr_b16 v[160:161], v40 offset:8192
    ds_read_b64_tr_b16 v[162:163], v40 offset:8704
    s_waitcnt lgkmcnt(10)
    v_mfma_f32_16x16x32_bf16 v[152:155], v[168:171], v[192:195], 0
    v_mfma_f32_16x16x32_bf16 v[76:79], v[52:55], v[192:195], 0
    ds_read_b64_tr_b16 v[164:165], v41 offset:8192
    ds_read_b64_tr_b16 v[166:167], v41 offset:8704
    v_mfma_f32_16x16x32_bf16 v[156:159], v[172:175], v[192:195], 0
    ds_read_b64_tr_b16 v[168:169], v42 offset:8192
    ds_read_b64_tr_b16 v[170:171], v42 offset:8704
    s_waitcnt lgkmcnt(10)
    v_mfma_f32_16x16x32_bf16 v[128:131], v[176:179], v[52:55], v[128:131]
    v_mfma_f32_16x16x32_bf16 v[144:147], v[176:179], v[196:199], v[144:147]
    ds_read_b64_tr_b16 v[172:173], v43 offset:8192
    ds_read_b64_tr_b16 v[174:175], v43 offset:8704
    v_mfma_f32_16x16x32_bf16 v[148:151], v[180:183], v[196:199], v[148:151]
    v_mfma_f32_16x16x32_bf16 v[80:83], v[196:199], v[196:199], v[80:83]
    ds_read_b64_tr_b16 v[176:177], v40 offset:12288
    ds_read_b64_tr_b16 v[178:179], v40 offset:12800
    s_waitcnt lgkmcnt(10)
    v_mfma_f32_16x16x32_bf16 v[152:155], v[184:187], v[196:199], v[152:155]
    v_mfma_f32_16x16x32_bf16 v[76:79], v[52:55], v[196:199], v[76:79]
    ds_read_b64_tr_b16 v[180:181], v41 offset:12288
    ds_read_b64_tr_b16 v[182:183], v41 offset:12800
    v_mfma_f32_16x16x32_bf16 v[156:159], v[188:191], v[196:199], v[156:159]
    ds_read_b64_tr_b16 v[184:185], v42 offset:12288
    ds_read_b64_tr_b16 v[186:187], v42 offset:12800
    s_waitcnt lgkmcnt(10)
    v_mfma_f32_16x16x32_bf16 v[128:131], v[160:163], v[52:55], v[128:131]
    v_mfma_f32_16x16x32_bf16 v[144:147], v[160:163], v[200:203], v[144:147]
    ds_read_b64_tr_b16 v[188:189], v43 offset:12288
    ds_read_b64_tr_b16 v[190:191], v43 offset:12800
    v_mfma_f32_16x16x32_bf16 v[148:151], v[164:167], v[200:203], v[148:151]
    v_mfma_f32_16x16x32_bf16 v[80:83], v[200:203], v[200:203], v[80:83]
    s_barrier
    ds_read_b128 v[208:211], v44 offset:4096
    ds_read_b128 v[212:215], v45 offset:4096
    ds_read_b128 v[216:219], v46 offset:4096
    s_waitcnt lgkmcnt(14)
    ds_read_b128 v[220:223], v47 offset:4096
    s_cmp_lg_u32 s69, 1
    s_cbranch_scc1 L_res_2
    s_waitcnt lgkmcnt(14)
    ds_read_b64 v[68:69], v48
    s_waitcnt lgkmcnt(14)
    ds_read_b64 v[70:71], v49
    s_waitcnt lgkmcnt(14)
    ds_read_b64 v[72:73], v50
    s_waitcnt lgkmcnt(14)
    ds_read_b64 v[74:75], v51
    s_waitcnt lgkmcnt(14)
    ds_read_b128 v[20:23], v64
    s_waitcnt lgkmcnt(14)
    ds_read_b128 v[24:27], v65
L_res_2:
    s_waitcnt lgkmcnt(14)
    ds_read_b64_tr_b16 v[160:161], v40 offset:16384
    s_waitcnt lgkmcnt(14)
    ds_read_b64_tr_b16 v[162:163], v40 offset:16896
    s_waitcnt lgkmcnt(14)
    v_mfma_f32_16x16x32_bf16 v[152:155], v[168:171], v[200:203], v[152:155]
    v_mfma_f32_16x16x32_bf16 v[76:79], v[52:55], v[200:203], v[76:79]
    ds_read_b64_tr_b16 v[164:165], v41 offset:16384
    s_waitcnt lgkmcnt(14)
    ds_read_b64_tr_b16 v[166:167], v41 offset:16896
    v_mfma_f32_16x16x32_bf16 v[156:159], v[172:175], v[200:203], v[156:159]
    s_waitcnt lgkmcnt(14)
    ds_read_b64_tr_b16 v[168:169], v42 offset:16384
    s_waitcnt lgkmcnt(14)
    ds_read_b64_tr_b16 v[170:171], v42 offset:16896
    s_waitcnt lgkmcnt(14)
    v_mfma_f32_16x16x32_bf16 v[128:131], v[176:179], v[52:55], v[128:131]
    v_mfma_f32_16x16x32_bf16 v[144:147], v[176:179], v[204:207], v[144:147]
    ds_read_b64_tr_b16 v[172:173], v43 offset:16384
    s_waitcnt lgkmcnt(14)
    ds_read_b64_tr_b16 v[174:175], v43 offset:16896
    v_mfma_f32_16x16x32_bf16 v[148:151], v[180:183], v[204:207], v[148:151]
    v_mfma_f32_16x16x32_bf16 v[80:83], v[204:207], v[204:207], v[80:83]
    s_waitcnt lgkmcnt(14)
    ds_read_b64_tr_b16 v[176:177], v40 offset:20480
    s_waitcnt lgkmcnt(14)
    ds_read_b64_tr_b16 v[178:179], v40 offset:20992
    s_waitcnt lgkmcnt(14)
    v_mfma_f32_16x16x32_bf16 v[152:155], v[184:187], v[204:207], v[152:155]
    v_mfma_f32_16x16x32_bf16 v[76:79], v[52:55], v[204:207], v[76:79]
    ds_read_b64_tr_b16 v[180:181], v41 offset:20480
    s_waitcnt lgkmcnt(14)
    ds_read_b64_tr_b16 v[182:183], v41 offset:20992
    v_mfma_f32_16x16x32_bf16 v[156:159], v[188:191], v[204:207], v[156:159]
    s_waitcnt lgkmcnt(12)
    ds_read_b64_tr_b16 v[184:185], v42 offset:20480
    ds_read_b64_tr_b16 v[186:187], v42 offset:20992
    s_waitcnt lgkmcnt(10)
    v_mfma_f32_16x16x32_bf16 v[128:131], v[160:163], v[52:55], v[128:131]
    v_mfma_f32_16x16x32_bf16 v[144:147], v[160:163], v[208:211], v[144:147]
    ds_read_b64_tr_b16 v[188:189], v43 offset:20480
    ds_read_b64_tr_b16 v[190:191], v43 offset:20992
    v_mfma_f32_16x16x32_bf16 v[148:151], v[164:167], v[208:211], v[148:151]
    v_mfma_f32_16x16x32_bf16 v[80:83], v[208:211], v[208:211], v[80:83]
    ds_read_b64_tr_b16 v[160:161], v40 offset:24576
    ds_read_b64_tr_b16 v[162:163], v40 offset:25088
    s_waitcnt lgkmcnt(10)
    v_mfma_f32_16x16x32_bf16 v[152:155], v[168:171], v[208:211], v[152:155]
    v_mfma_f32_16x16x32_bf16 v[76:79], v[52:55], v[208:211], v[76:79]
    ds_read_b64_tr_b16 v[164:165], v41 offset:24576
    ds_read_b64_tr_b16 v[166:167], v41 offset:25088
    v_mfma_f32_16x16x32_bf16 v[156:159], v[172:175], v[208:211], v[156:159]
    ds_read_b64_tr_b16 v[168:169], v42 offset:24576
    ds_read_b64_tr_b16 v[170:171], v42 offset:25088
    s_waitcnt lgkmcnt(10)
    v_mfma_f32_16x16x32_bf16 v[128:131], v[176:179], v[52:55], v[128:131]
    v_mfma_f32_16x16x32_bf16 v[144:147], v[176:179], v[212:215], v[144:147]
    ds_read_b64_tr_b16 v[172:173], v43 offset:24576
    ds_read_b64_tr_b16 v[174:175], v43 offset:25088
    v_mfma_f32_16x16x32_bf16 v[148:151], v[180:183], v[212:215], v[148:151]
    v_mfma_f32_16x16x32_bf16 v[80:83], v[212:215], v[212:215], v[80:83]
    ds_read_b64_tr_b16 v[176:177], v40 offset:28672
    ds_read_b64_tr_b16 v[178:179], v40 offset:29184
    s_waitcnt lgkmcnt(10)
    v_mfma_f32_16x16x32_bf16 v[152:155], v[184:187], v[212:215], v[152:155]
    v_mfma_f32_16x16x32_bf16 v[76:79], v[52:55], v[212:215], v[76:79]
    ds_read_b64_tr_b16 v[180:181], v41 offset:28672
    ds_read_b64_tr_b16 v[182:183], v41 offset:29184
    v_mfma_f32_16x16x32_bf16 v[156:159], v[188:191], v[212:215], v[156:159]
    ds_read_b64_tr_b16 v[184:185], v42 offset:28672
    ds_read_b64_tr_b16 v[186:187], v42 offset:29184
    s_waitcnt lgkmcnt(10)
    v_mfma_f32_16x16x32_bf16 v[128:131], v[160:163], v[52:55], v[128:131]
    v_mfma_f32_16x16x32_bf16 v[144:147], v[160:163], v[216:219], v[144:147]
    ds_read_b64_tr_b16 v[188:189], v43 offset:28672
    ds_read_b64_tr_b16 v[190:191], v43 offset:29184
    v_mfma_f32_16x16x32_bf16 v[148:151], v[164:167], v[216:219], v[148:151]
    v_mfma_f32_16x16x32_bf16 v[80:83], v[216:219], v[216:219], v[80:83]
    s_barrier
    ds_read_b128 v[224:227], v44 offset:8192
    ds_read_b128 v[228:231], v45 offset:8192
    ds_read_b128 v[232:235], v46 offset:8192
    s_waitcnt lgkmcnt(14)
    ds_read_b128 v[236:239], v47 offset:8192
    s_cmp_lg_u32 s69, 2
    s_cbranch_scc1 L_res_3
    s_waitcnt lgkmcnt(14)
    ds_read_b64 v[68:69], v48
    s_waitcnt lgkmcnt(14)
    ds_read_b64 v[70:71], v49
    s_waitcnt lgkmcnt(14)
    ds_read_b64 v[72:73], v50
    s_waitcnt lgkmcnt(14)
    ds_read_b64 v[74:75], v51
    s_waitcnt lgkmcnt(14)
    ds_read_b128 v[20:23], v64
    s_waitcnt lgkmcnt(14)
    ds_read_b128 v[24:27], v65
L_res_3:
    s_waitcnt lgkmcnt(14)
    ds_read_b64_tr_b16 v[160:161], v40 offset:32768
    s_waitcnt lgkmcnt(14)
    ds_read_b64_tr_b16 v[162:163], v40 offset:33280
    s_waitcnt lgkmcnt(14)
    v_mfma_f32_16x16x32_bf16 v[152:155], v[168:171], v[216:219], v[152:155]
    v_mfma_f32_16x16x32_bf16 v[76:79], v[52:55], v[216:219], v[76:79]
    ds_read_b64_tr_b16 v[164:165], v41 offset:32768
    s_waitcnt lgkmcnt(14)
    ds_read_b64_tr_b16 v[166:167], v41 offset:33280
    v_mfma_f32_16x16x32_bf16 v[156:159], v[172:175], v[216:219], v[156:159]
    s_waitcnt lgkmcnt(14)
    ds_read_b64_tr_b16 v[168:169], v42 offset:32768
    s_waitcnt lgkmcnt(14)
    ds_read_b64_tr_b16 v[170:171], v42 offset:33280
    s_waitcnt lgkmcnt(14)
    v_mfma_f32_16x16x32_bf16 v[128:131], v[176:179], v[52:55], v[128:131]
    v_mfma_f32_16x16x32_bf16 v[144:147], v[176:179], v[220:223], v[144:147]
    ds_read_b64_tr_b16 v[172:173], v43 offset:32768
    s_waitcnt lgkmcnt(14)
    ds_read_b64_tr_b16 v[174:175], v43 offset:33280
    v_mfma_f32_16x16x32_bf16 v[148:151], v[180:183], v[220:223], v[148:151]
    v_mfma_f32_16x16x32_bf16 v[80:83], v[220:223], v[220:223], v[80:83]
    s_waitcnt lgkmcnt(14)
    ds_read_b64_tr_b16 v[176:177], v40 offset:36864
    s_waitcnt lgkmcnt(14)
    ds_read_b64_tr_b16 v[178:179], v40 offset:37376
    s_waitcnt lgkmcnt(14)
    v_mfma_f32_16x16x32_bf16 v[152:155], v[184:187], v[220:223], v[152:155]
    v_and_b32 v1, 15, v0
    v_lshlrev_b32 v1, 2, v1
    buffer_load_dword v2, v1, s[28:31], s68 offen sc1
    v_mfma_f32_16x16x32_bf16 v[76:79], v[52:55], v[220:223], v[76:79]
    ds_read_b64_tr_b16 v[180:181], v41 offset:36864
    s_waitcnt lgkmcnt(14)
    ds_read_b64_tr_b16 v[182:183], v41 offset:37376
    v_mfma_f32_16x16x32_bf16 v[156:159], v[188:191], v[220:223], v[156:159]
    s_waitcnt lgkmcnt(12)
    ds_read_b64_tr_b16 v[184:185], v42 offset:36864
    ds_read_b64_tr_b16 v[186:187], v42 offset:37376
    s_waitcnt lgkmcnt(10)
    v_mfma_f32_16x16x32_bf16 v[128:131], v[160:163], v[52:55], v[128:131]
    v_mfma_f32_16x16x32_bf16 v[144:147], v[160:163], v[224:227], v[144:147]
    ds_read_b64_tr_b16 v[188:189], v43 offset:36864
    ds_read_b64_tr_b16 v[190:191], v43 offset:37376
    v_mfma_f32_16x16x32_bf16 v[148:151], v[164:167], v[224:227], v[148:151]
    v_mfma_f32_16x16x32_bf16 v[80:83], v[224:227], v[224:227], v[80:83]
    ds_read_b64_tr_b16 v[160:161], v40 offset:40960
    ds_read_b64_tr_b16 v[162:163], v40 offset:41472
    s_waitcnt lgkmcnt(10)
    v_mfma_f32_16x16x32_bf16 v[152:155], v[168:171], v[224:227], v[152:155]
    v_mfma_f32_16x16x32_bf16 v[76:79], v[52:55], v[224:227], v[76:79]
    ds_read_b64_tr_b16 v[164:165], v41 offset:40960
    ds_read_b64_tr_b16 v[166:167], v41 offset:41472
    v_mfma_f32_16x16x32_bf16 v[156:159], v[172:175], v[224:227], v[156:159]
    ds_read_b64_tr_b16 v[168:169], v42 offset:40960
    ds_read_b64_tr_b16 v[170:171], v42 offset:41472
    s_waitcnt lgkmcnt(10)
    v_mfma_f32_16x16x32_bf16 v[128:131], v[176:179], v[52:55], v[128:131]
    v_mfma_f32_16x16x32_bf16 v[144:147], v[176:179], v[228:231], v[144:147]
    ds_read_b64_tr_b16 v[172:173], v43 offset:40960
    ds_read_b64_tr_b16 v[174:175], v43 offset:41472
    v_mfma_f32_16x16x32_bf16 v[148:151], v[180:183], v[228:231], v[148:151]
    v_mfma_f32_16x16x32_bf16 v[80:83], v[228:231], v[228:231], v[80:83]
    ds_read_b64_tr_b16 v[176:177], v40 offset:45056
    ds_read_b64_tr_b16 v[178:179], v40 offset:45568
    s_waitcnt lgkmcnt(10)
    v_mfma_f32_16x16x32_bf16 v[152:155], v[184:187], v[228:231], v[152:155]
    v_mfma_f32_16x16x32_bf16 v[76:79], v[52:55], v[228:231], v[76:79]
    ds_read_b64_tr_b16 v[180:181], v41 offset:45056
    ds_read_b64_tr_b16 v[182:183], v41 offset:45568
    v_mfma_f32_16x16x32_bf16 v[156:159], v[188:191], v[228:231], v[156:159]
    ds_read_b64_tr_b16 v[184:185], v42 offset:45056
    ds_read_b64_tr_b16 v[186:187], v42 offset:45568
    s_waitcnt lgkmcnt(10)
    v_mfma_f32_16x16x32_bf16 v[128:131], v[160:163], v[52:55], v[128:131]
    v_mfma_f32_16x16x32_bf16 v[144:147], v[160:163], v[232:235], v[144:147]
    ds_read_b64_tr_b16 v[188:189], v43 offset:45056
    ds_read_b64_tr_b16 v[190:191], v43 offset:45568
    v_mfma_f32_16x16x32_bf16 v[148:151], v[164:167], v[232:235], v[148:151]
    v_mfma_f32_16x16x32_bf16 v[80:83], v[232:235], v[232:235], v[80:83]
    s_waitcnt vmcnt(1)
    s_barrier
    ds_read_b128 v[240:243], v44 offset:12288
    ds_read_b128 v[244:247], v45 offset:12288
    ds_read_b128 v[248:251], v46 offset:12288
    s_waitcnt lgkmcnt(14)
    ds_read_b128 v[252:255], v47 offset:12288
    s_cmp_lg_u32 s69, 3
    s_cbranch_scc1 L_res_4
    s_waitcnt lgkmcnt(14)
    ds_read_b64 v[68:69], v48
    s_waitcnt lgkmcnt(14)
    ds_read_b64 v[70:71], v49
    s_waitcnt lgkmcnt(14)
    ds_read_b64 v[72:73], v50
    s_waitcnt lgkmcnt(14)
    ds_read_b64 v[74:75], v51
    s_waitcnt lgkmcnt(14)
    ds_read_b128 v[20:23], v64
    s_waitcnt lgkmcnt(14)
    ds_read_b128 v[24:27], v65
L_res_4:
    s_waitcnt lgkmcnt(14)
    ds_read_b64_tr_b16 v[160:161], v40 offset:49152
    s_waitcnt lgkmcnt(14)
    ds_read_b64_tr_b16 v[162:163], v40 offset:49664
    s_waitcnt lgkmcnt(14)
    v_mfma_f32_16x16x32_bf16 v[152:155], v[168:171], v[232:235], v[152:155]
    v_mfma_f32_16x16x32_bf16 v[76:79], v[52:55], v[232:235], v[76:79]
    ds_read_b64_tr_b16 v[164:165], v40 offset:53248
    s_waitcnt lgkmcnt(14)
    ds_read_b64_tr_b16 v[166:167], v40 offset:53760
    v_mfma_f32_16x16x32_bf16 v[156:159], v[172:175], v[232:235], v[156:159]
    s_waitcnt lgkmcnt(14)
    ds_read_b64_tr_b16 v[168:169], v40 offset:57344
    s_waitcnt lgkmcnt(14)
    ds_read_b64_tr_b16 v[170:171], v40 offset:57856
    s_waitcnt lgkmcnt(14)
    v_mfma_f32_16x16x32_bf16 v[128:131], v[176:179], v[52:55], v[128:131]
    v_mfma_f32_16x16x32_bf16 v[144:147], v[176:179], v[236:239], v[144:147]
    ds_read_b64_tr_b16 v[172:173], v40 offset:61440
    s_waitcnt lgkmcnt(14)
    ds_read_b64_tr_b16 v[174:175], v40 offset:61952
    v_mfma_f32_16x16x32_bf16 v[148:151], v[180:183], v[236:239], v[148:151]
    v_mfma_f32_16x16x32_bf16 v[80:83], v[236:239], v[236:239], v[80:83]
    s_waitcnt lgkmcnt(14)
    ds_read_b64_tr_b16 v[176:177], v41 offset:49152
    s_waitcnt lgkmcnt(14)
    ds_read_b64_tr_b16 v[178:179], v41 offset:49664
    s_waitcnt lgkmcnt(14)
    v_mfma_f32_16x16x32_bf16 v[152:155], v[184:187], v[236:239], v[152:155]
    v_mfma_f32_16x16x32_bf16 v[76:79], v[52:55], v[236:239], v[76:79]
    ds_read_b64_tr_b16 v[180:181], v42 offset:49152
    s_waitcnt lgkmcnt(14)
    ds_read_b64_tr_b16 v[182:183], v42 offset:49664
    v_mfma_f32_16x16x32_bf16 v[156:159], v[188:191], v[236:239], v[156:159]
    s_waitcnt lgkmcnt(12)
    v_mfma_f32_16x16x32_bf16 v[80:83], v[240:243], v[240:243], v[80:83]
    v_mfma_f32_16x16x32_bf16 v[76:79], v[52:55], v[240:243], v[76:79]
    v_mfma_f32_16x16x32_bf16 v[80:83], v[244:247], v[244:247], v[80:83]
    v_mfma_f32_16x16x32_bf16 v[76:79], v[52:55], v[244:247], v[76:79]
    v_mfma_f32_16x16x32_bf16 v[80:83], v[248:251], v[248:251], v[80:83]
    v_mfma_f32_16x16x32_bf16 v[76:79], v[52:55], v[248:251], v[76:79]
    v_mfma_f32_16x16x32_bf16 v[80:83], v[252:255], v[252:255], v[80:83]
    v_mfma_f32_16x16x32_bf16 v[76:79], v[52:55], v[252:255], v[76:79]
    ds_read_b64_tr_b16 v[184:185], v43 offset:49152
    ds_read_b64_tr_b16 v[186:187], v43 offset:49664
    s_waitcnt lgkmcnt(10)
    v_mfma_f32_16x16x32_bf16 v[128:131], v[160:163], v[52:55], v[128:131]
    v_mfma_f32_16x16x32_bf16 v[144:147], v[160:163], v[240:243], v[144:147]
    ds_read_b64_tr_b16 v[188:189], v41 offset:53248
    ds_read_b64_tr_b16 v[190:191], v41 offset:53760
    v_mfma_f32_16x16x32_bf16 v[128:131], v[164:167], v[52:55], v[128:131]
    v_mfma_f32_16x16x32_bf16 v[144:147], v[164:167], v[244:247], v[144:147]
    v_cndmask_b32 v62, v80, v81, s[72:73]
    v_mov_b32 v60, v76
    v_cndmask_b32 v62, v62, v82, s[74:75]
    v_cndmask_b32 v62, v62, v83, s[76:77]
    ds_read_b64_tr_b16 v[160:161], v42 offset:53248
    ds_read_b64_tr_b16 v[162:163], v42 offset:53760
    s_waitcnt lgkmcnt(10)
    v_mfma_f32_16x16x32_bf16 v[128:131], v[168:171], v[52:55], v[128:131]
    v_mfma_f32_16x16x32_bf16 v[144:147], v[168:171], v[248:251], v[144:147]
    v_cndmask_b32 v62, 0, v62, s[70:71]
    v_mov_b32 v63, v62
    s_nop 1
    v_permlane32_swap_b32 v62, v63
    v_add_f32 v62, v62, v63
    ds_read_b64_tr_b16 v[164:165], v43 offset:53248
    ds_read_b64_tr_b16 v[166:167], v43 offset:53760
    v_mfma_f32_16x16x32_bf16 v[128:131], v[172:175], v[52:55], v[128:131]
    v_mfma_f32_16x16x32_bf16 v[144:147], v[172:175], v[252:255], v[144:147]
    v_mov_b32 v63, v62
    s_nop 1
    v_permlane16_swap_b32 v62, v63
    v_add_f32 v62, v62, v63
    v_mul_f32 v60, 0x3b000000, v60
    ds_read_b64_tr_b16 v[168:169], v41 offset:57344
    ds_read_b64_tr_b16 v[170:171], v41 offset:57856
    s_waitcnt lgkmcnt(10)
    v_mfma_f32_16x16x32_bf16 v[148:151], v[176:179], v[240:243], v[148:151]
    v_mul_f32 v62, 0x3b000000, v62
    v_fma_f32 v62, -v60, v60, v62
    v_max_f32 v62, 0, v62
    v_add_f32 v61, 0x3727c5ac, v62
    ds_read_b64_tr_b16 v[172:173], v42 offset:57344
    ds_read_b64_tr_b16 v[174:175], v42 offset:57856
    v_mfma_f32_16x16x32_bf16 v[152:155], v[180:183], v[240:243], v[152:155]
    v_rsq_f32 v61, v61
    v_sub_f32 v12, 0, v60
    v_mul_f32 v62, v62, v61
    s_mov_b64 exec, 0xffff
    ds_write_b32 v11, v60
    ds_write_b32 v11, v61 offset:288
    s_mov_b64 exec, -1
    ds_read_b64_tr_b16 v[176:177], v43 offset:57344
    s_waitcnt lgkmcnt(14)
    ds_read_b64_tr_b16 v[178:179], v43 offset:57856
    s_waitcnt lgkmcnt(12)
    v_mfma_f32_16x16x32_bf16 v[156:159], v[184:187], v[240:243], v[156:159]
    s_mov_b32 exec_lo, 0x00010001
    s_mov_b32 exec_hi, 0x00010001
    ds_write_b128 v56, v[128:131]
    s_mov_b64 exec, -1
    v_mul_f32 v62, v62, v61
    v_add_f32 v62, 0x3727c5ac, v62
    v_rsq_f32 v62, v62
    s_nop 0
    v_mul_f32 v62, v62, v61
    ds_read_b64_tr_b16 v[180:181], v41 offset:61440
    ds_read_b64_tr_b16 v[182:183], v41 offset:61952
    v_mfma_f32_16x16x32_bf16 v[148:151], v[188:191], v[244:247], v[148:151]
    v_rcp_f32 v18, v62
    v_mul_f32 v16, 0xc0135761, v62
    v_mul_f32 v61, v62, v62
    v_mul_f32 v61, v61, v62
    s_waitcnt lgkmcnt(14)
    ds_read_b64_tr_b16 v[184:185], v42 offset:61440
    s_waitcnt lgkmcnt(14)
    ds_read_b64_tr_b16 v[186:187], v42 offset:61952
    s_waitcnt lgkmcnt(13)
    v_mfma_f32_16x16x32_bf16 v[152:155], v[160:163], v[244:247], v[152:155]
    v_mul_f32 v14, 0xbdd2d3e8, v61
    ds_read_b64_tr_b16 v[188:189], v43 offset:61440
    ds_read_b64_tr_b16 v[190:191], v43 offset:61952
    v_mfma_f32_16x16x32_bf16 v[156:159], v[164:167], v[244:247], v[156:159]
    s_waitcnt lgkmcnt(11)
    v_mfma_f32_16x16x32_bf16 v[148:151], v[168:171], v[248:251], v[148:151]
    s_waitcnt lgkmcnt(0)
    s_barrier
    ds_read_b128 v[132:135], v57
    ds_read_b128 v[136:139], v58
    ds_read_b128 v[140:143], v59
    v_mfma_f32_16x16x32_bf16 v[152:155], v[172:175], v[248:251], v[152:155]
    s_waitcnt lgkmcnt(7)
    v_mfma_f32_16x16x32_bf16 v[156:159], v[176:179], v[248:251], v[156:159]
    v_mfma_f32_16x16x32_bf16 v[148:151], v[180:183], v[252:255], v[148:151]
    s_waitcnt lgkmcnt(3)
    v_mfma_f32_16x16x32_bf16 v[152:155], v[184:187], v[252:255], v[152:155]
    v_mfma_f32_16x16x32_bf16 v[156:159], v[188:191], v[252:255], v[156:159]
    v_pk_fma_f32 v[144:145], v[128:129], v[12:13], v[144:145] op_sel_hi:[1,0,1]
    v_pk_fma_f32 v[146:147], v[130:131], v[12:13], v[146:147] op_sel_hi:[1,0,1]
    v_pk_mul_f32 v[28:29], v[144:145], v[144:145]
    v_pk_mul_f32 v[30:31], v[146:147], v[146:147]
    v_pk_fma_f32 v[28:29], v[28:29], v[14:15], v[16:17] op_sel_hi:[1,0,0]
    v_pk_fma_f32 v[30:31], v[30:31], v[14:15], v[16:17] op_sel_hi:[1,0,0]
    v_pk_mul_f32 v[28:29], v[28:29], v[144:145]
    v_pk_mul_f32 v[30:31], v[30:31], v[146:147]
    v_exp_f32 v28, v28
    v_exp_f32 v30, v30
    v_exp_f32 v29, v29
    v_exp_f32 v31, v31
    v_pk_fma_f32 v[28:29], v[28:29], v[18:19], v[18:19] op_sel_hi:[1,0,0]
    v_pk_fma_f32 v[30:31], v[30:31], v[18:19], v[18:19] op_sel_hi:[1,0,0]
    v_rcp_f32 v28, v28
    v_rcp_f32 v30, v30
    v_rcp_f32 v29, v29
    v_rcp_f32 v31, v31
    v_pk_mul_f32 v[28:29], v[28:29], v[144:145]
    v_pk_mul_f32 v[30:31], v[30:31], v[146:147]
    v_cvt_pk_bf16_f32 v32, v28, v29
    v_cvt_pk_bf16_f32 v33, v30, v31
    s_waitcnt vmcnt(0) lgkmcnt(0)
    v_cmp_ne_u32 vcc, s66, v2
    s_nop 1
    s_cmp_eq_u64 vcc, 0
    s_cselect_b32 s64, 1, 0
    v_pk_fma_f32 v[148:149], v[132:133], v[12:13], v[148:149] op_sel_hi:[1,0,1]
    v_pk_fma_f32 v[150:151], v[134:135], v[12:13], v[150:151] op_sel_hi:[1,0,1]
    v_pk_mul_f32 v[28:29], v[148:149], v[148:149]
    v_pk_mul_f32 v[30:31], v[150:151], v[150:151]
    v_pk_fma_f32 v[28:29], v[28:29], v[14:15], v[16:17] op_sel_hi:[1,0,0]
    v_pk_fma_f32 v[30:31], v[30:31], v[14:15], v[16:17] op_sel_hi:[1,0,0]
    v_pk_mul_f32 v[28:29], v[28:29], v[148:149]
    v_pk_mul_f32 v[30:31], v[30:31], v[150:151]
    v_exp_f32 v28, v28
    v_exp_f32 v30, v30
    v_exp_f32 v29, v29
    v_exp_f32 v31, v31
    v_pk_fma_f32 v[28:29], v[28:29], v[18:19], v[18:19] op_sel_hi:[1,0,0]
    v_pk_fma_f32 v[30:31], v[30:31], v[18:19], v[18:19] op_sel_hi:[1,0,0]
    v_rcp_f32 v28, v28
    v_rcp_f32 v30, v30
    v_rcp_f32 v29, v29
    v_rcp_f32 v31, v31
    v_pk_mul_f32 v[28:29], v[28:29], v[148:149]
    v_pk_mul_f32 v[30:31], v[30:31], v[150:151]
    v_cvt_pk_bf16_f32 v34, v28, v29
    v_cvt_pk_bf16_f32 v35, v30, v31
    v_pk_fma_f32 v[152:153], v[136:137], v[12:13], v[152:153] op_sel_hi:[1,0,1]
    v_pk_fma_f32 v[154:155], v[138:139], v[12:13], v[154:155] op_sel_hi:[1,0,1]
    v_pk_mul_f32 v[28:29], v[152:153], v[152:153]
    v_pk_mul_f32 v[30:31], v[154:155], v[154:155]
    v_pk_fma_f32 v[28:29], v[28:29], v[14:15], v[16:17] op_sel_hi:[1,0,0]
    v_pk_fma_f32 v[30:31], v[30:31], v[14:15], v[16:17] op_sel_hi:[1,0,0]
    v_pk_mul_f32 v[28:29], v[28:29], v[152:153]
    v_pk_mul_f32 v[30:31], v[30:31], v[154:155]
    v_exp_f32 v28, v28
    v_exp_f32 v30, v30
    v_exp_f32 v29, v29
    v_exp_f32 v31, v31
    v_pk_fma_f32 v[28:29], v[28:29], v[18:19], v[18:19] op_sel_hi:[1,0,0]
    v_pk_fma_f32 v[30:31], v[30:31], v[18:19], v[18:19] op_sel_hi:[1,0,0]
    v_rcp_f32 v28, v28
    v_rcp_f32 v30, v30
    v_rcp_f32 v29, v29
    v_rcp_f32 v31, v31
    v_pk_mul_f32 v[28:29], v[28:29], v[152:153]
    v_pk_mul_f32 v[30:31], v[30:31], v[154:155]
    v_cvt_pk_bf16_f32 v36, v28, v29
    v_cvt_pk_bf16_f32 v37, v30, v31
    v_pk_fma_f32 v[156:157], v[140:141], v[12:13], v[156:157] op_sel_hi:[1,0,1]
    v_pk_fma_f32 v[158:159], v[142:143], v[12:13], v[158:159] op_sel_hi:[1,0,1]
    v_pk_mul_f32 v[28:29], v[156:157], v[156:157]
    v_pk_mul_f32 v[30:31], v[158:159], v[158:159]
    v_pk_fma_f32 v[28:29], v[28:29], v[14:15], v[16:17] op_sel_hi:[1,0,0]
    v_pk_fma_f32 v[30:31], v[30:31], v[14:15], v[16:17] op_sel_hi:[1,0,0]
    v_pk_mul_f32 v[28:29], v[28:29], v[156:157]
    v_pk_mul_f32 v[30:31], v[30:31], v[158:159]
    v_exp_f32 v28, v28
    v_exp_f32 v30, v30
    v_exp_f32 v29, v29
    v_exp_f32 v31, v31
    v_pk_fma_f32 v[28:29], v[28:29], v[18:19], v[18:19] op_sel_hi:[1,0,0]
    v_pk_fma_f32 v[30:31], v[30:31], v[18:19], v[18:19] op_sel_hi:[1,0,0]
    v_rcp_f32 v28, v28
    v_rcp_f32 v30, v30
    v_rcp_f32 v29, v29
    v_rcp_f32 v31, v31
    v_pk_mul_f32 v[28:29], v[28:29], v[156:157]
    v_pk_mul_f32 v[30:31], v[30:31], v[158:159]
    v_cvt_pk_bf16_f32 v38, v28, v29
    v_cvt_pk_bf16_f32 v39, v30, v31
    s_mov_b64 exec, s[58:59]
    s_cbranch_execz L_nozero_5
    v_mov_b32 v32, 0
    v_mov_b32 v33, 0
    v_mov_b32 v34, 0
    v_mov_b32 v35, 0
    v_mov_b32 v36, 0
    v_mov_b32 v37, 0
    v_mov_b32 v38, 0
    v_mov_b32 v39, 0
L_nozero_5:
    s_mov_b64 exec, -1
    s_nop 0
    v_permlane16_swap_b32 v32, v34
    v_permlane16_swap_b32 v33, v35
    v_permlane16_swap_b32 v36, v38
    v_permlane16_swap_b32 v37, v39
    buffer_store_dwordx4 v[32:35], v17, s[28:31], s60 offen sc1
    buffer_store_dwordx4 v[36:39], v17, s[28:31], s61 offen sc1
    v_lshlrev_b32 v144, 16, v68
    v_and_b32 v145, 0xffff0000, v68
    v_lshlrev_b32 v146, 16, v69
    v_and_b32 v147, 0xffff0000, v69
    v_lshlrev_b32 v148, 16, v70
    v_and_b32 v149, 0xffff0000, v70
    v_lshlrev_b32 v150, 16, v71
    v_and_b32 v151, 0xffff0000, v71
    v_lshlrev_b32 v152, 16, v72
    v_and_b32 v153, 0xffff0000, v72
    v_lshlrev_b32 v154, 16, v73
    v_and_b32 v155, 0xffff0000, v73
    v_lshlrev_b32 v156, 16, v74
    v_and_b32 v157, 0xffff0000, v74
    v_lshlrev_b32 v158, 16, v75
    v_and_b32 v159, 0xffff0000, v75
    v_subrev_u32 v40, 65536, v40
    v_subrev_u32 v41, 65536, v41
    v_subrev_u32 v42, 65536, v42
    v_subrev_u32 v43, 65536, v43
    s_lshl_b32 s50, s41, 8
    v_lshl_add_u32 v1, v8, 4, s50
    v_lshl_add_u32 v44, v9, 10, v1
    v_add_u32 v45, 4096, v44
    v_add_u32 v46, 8192, v44
    v_add_u32 v47, 12288, v44
    s_lshl_b32 s66, s42, 16
    s_add_u32 s66, s66, 1048576
    s_lshl_b32 s63, s42, 7
    s_add_u32 s63, s63, 4096
    s_lshl_b32 s65, s43, 2
    s_add_u32 s65, s65, s63
    s_add_u32 s60, s60, 2097152
    s_add_u32 s61, s61, 2097152
    s_waitcnt vmcnt(0) lgkmcnt(0)
    s_barrier
    s_cmp_lg_u32 s41, 0
    s_cbranch_scc1 L_ho_6
    s_mov_b64 exec, 1
    s_cmp_eq_u32 s64, 0
    s_cbranch_scc1 L_hof_7
    buffer_store_dword v13, v15, s[28:31], s65 offen
    s_branch L_hop_8_a
L_hof_7:
    buffer_store_dword v13, v15, s[28:31], s65 offen sc1
L_hop_8_a:
    s_mov_b64 exec, -1
L_ho_6:
    s_barrier
    s_lshl_b32 s50, s41, 6
    s_add_u32 s50, s50, 162064
    v_lshl_add_u32 v3, v8, 2, s50
    ds_read_b32 v28, v3
    ds_read_b32 v29, v3 offset:288
    ds_read_b64_tr_b16 v[176:177], v40 offset:0
    ds_read_b64_tr_b16 v[178:179], v40 offset:512
    ds_read_b64_tr_b16 v[180:181], v41 offset:0
    ds_read_b64_tr_b16 v[182:183], v41 offset:512
    ds_read_b64_tr_b16 v[184:185], v42 offset:0
    ds_read_b64_tr_b16 v[186:187], v42 offset:512
    ds_read_b64_tr_b16 v[188:189], v43 offset:0
    ds_read_b64_tr_b16 v[190:191], v43 offset:512
    ds_read_b64_tr_b16 v[160:161], v40 offset:4096
    ds_read_b64_tr_b16 v[162:163], v40 offset:4608
    ds_read_b64_tr_b16 v[164:165], v41 offset:4096
    s_waitcnt lgkmcnt(11)
    ds_read_b64_tr_b16 v[166:167], v41 offset:4608
    ds_read_b64_tr_b16 v[168:169], v42 offset:4096
    ds_read_b64_tr_b16 v[170:171], v42 offset:4608
    ds_read_b64_tr_b16 v[172:173], v43 offset:4096
    v_mul_f32 v28, v28, v29
    s_waitcnt lgkmcnt(14)
    ds_read_b64_tr_b16 v[174:175], v43 offset:4608
    s_waitcnt lgkmcnt(14)
    ds_read_b64_tr_b16 v[128:129], v40 offset:8192
    v_fma_f32 v144, v144, v29, -v28
    s_waitcnt lgkmcnt(14)
    ds_read_b64_tr_b16 v[130:131], v40 offset:8704
    s_waitcnt lgkmcnt(14)
    ds_read_b64_tr_b16 v[132:133], v41 offset:8192
    s_waitcnt lgkmcnt(14)
    ds_read_b64_tr_b16 v[134:135], v41 offset:8704
    s_waitcnt lgkmcnt(14)
    ds_read_b64_tr_b16 v[136:137], v42 offset:8192
    v_fma_f32 v145, v145, v29, -v28
    s_waitcnt lgkmcnt(14)
    ds_read_b64_tr_b16 v[138:139], v42 offset:8704
    s_waitcnt lgkmcnt(14)
    ds_read_b64_tr_b16 v[140:141], v43 offset:8192
    s_waitcnt lgkmcnt(14)
    ds_read_b64_tr_b16 v[142:143], v43 offset:8704
    v_fma_f32 v146, v146, v29, -v28
    s_waitcnt lgkmcnt(14)
    ds_read_b64_tr_b16 v[112:113], v40 offset:12288
    s_waitcnt lgkmcnt(14)
    ds_read_b64_tr_b16 v[114:115], v40 offset:12800
    s_waitcnt lgkmcnt(14)
    ds_read_b64_tr_b16 v[116:117], v41 offset:12288
    v_fma_f32 v147, v147, v29, -v28
    s_waitcnt lgkmcnt(14)
    ds_read_b64_tr_b16 v[118:119], v41 offset:12800
    s_waitcnt lgkmcnt(14)
    ds_read_b64_tr_b16 v[120:121], v42 offset:12288
    s_waitcnt lgkmcnt(14)
    ds_read_b64_tr_b16 v[122:123], v42 offset:12800
    v_fma_f32 v148, v148, v29, -v28
    s_waitcnt lgkmcnt(14)
    ds_read_b64_tr_b16 v[124:125], v43 offset:12288
    s_waitcnt lgkmcnt(14)
    ds_read_b64_tr_b16 v[126:127], v43 offset:12800
    s_waitcnt lgkmcnt(14)
    ds_read_b64_tr_b16 v[96:97], v40 offset:16384
    v_fma_f32 v149, v149, v29, -v28
    s_waitcnt lgkmcnt(14)
    ds_read_b64_tr_b16 v[98:99], v40 offset:16896
    s_waitcnt lgkmcnt(14)
    ds_read_b64_tr_b16 v[100:101], v41 offset:16384
    s_waitcnt lgkmcnt(14)
    ds_read_b64_tr_b16 v[102:103], v41 offset:16896
    v_fma_f32 v150, v150, v29, -v28
    s_waitcnt lgkmcnt(14)
    ds_read_b64_tr_b16 v[104:105], v42 offset:16384
    s_waitcnt lgkmcnt(14)
    ds_read_b64_tr_b16 v[106:107], v42 offset:16896
    s_waitcnt lgkmcnt(14)
    ds_read_b64_tr_b16 v[108:109], v43 offset:16384
    s_waitcnt lgkmcnt(14)
    ds_read_b64_tr_b16 v[110:111], v43 offset:16896
    v_fma_f32 v151, v151, v29, -v28
    s_waitcnt lgkmcnt(14)
    ds_read_b64_tr_b16 v[80:81], v40 offset:20480
    s_waitcnt lgkmcnt(14)
    ds_read_b64_tr_b16 v[82:83], v40 offset:20992
    s_waitcnt lgkmcnt(14)
    ds_read_b64_tr_b16 v[84:85], v41 offset:20480
    v_fma_f32 v152, v152, v29, -v28
    s_waitcnt lgkmcnt(14)
    ds_read_b64_tr_b16 v[86:87], v41 offset:20992
    s_waitcnt lgkmcnt(14)
    ds_read_b64_tr_b16 v[88:89], v42 offset:20480
    s_waitcnt lgkmcnt(14)
    ds_read_b64_tr_b16 v[90:91], v42 offset:20992
    v_fma_f32 v153, v153, v29, -v28
    s_waitcnt lgkmcnt(14)
    ds_read_b64_tr_b16 v[92:93], v43 offset:20480
    s_waitcnt lgkmcnt(14)
    ds_read_b64_tr_b16 v[94:95], v43 offset:20992
    s_waitcnt lgkmcnt(14)
    ds_read_b64_tr_b16 v[64:65], v40 offset:24576
    v_fma_f32 v154, v154, v29, -v28
    s_waitcnt lgkmcnt(14)
    ds_read_b64_tr_b16 v[66:67], v40 offset:25088
    s_waitcnt lgkmcnt(14)
    ds_read_b64_tr_b16 v[68:69], v41 offset:24576
    s_waitcnt lgkmcnt(14)
    ds_read_b64_tr_b16 v[70:71], v41 offset:25088
    v_fma_f32 v155, v155, v29, -v28
    s_waitcnt lgkmcnt(14)
    ds_read_b64_tr_b16 v[72:73], v42 offset:24576
    s_waitcnt lgkmcnt(14)
    ds_read_b64_tr_b16 v[74:75], v42 offset:25088
    s_waitcnt lgkmcnt(14)
    ds_read_b64_tr_b16 v[76:77], v43 offset:24576
    s_waitcnt lgkmcnt(14)
    ds_read_b64_tr_b16 v[78:79], v43 offset:25088
    v_fma_f32 v156, v156, v29, -v28
    s_waitcnt lgkmcnt(14)
    ds_read_b64_tr_b16 v[48:49], v40 offset:28672
    s_waitcnt lgkmcnt(14)
    ds_read_b64_tr_b16 v[50:51], v40 offset:29184
    v_fma_f32 v157, v157, v29, -v28
    s_waitcnt lgkmcnt(14)
    ds_read_b64_tr_b16 v[52:53], v41 offset:28672
    s_waitcnt lgkmcnt(14)
    ds_read_b64_tr_b16 v[54:55], v41 offset:29184
    s_waitcnt lgkmcnt(14)
    ds_read_b64_tr_b16 v[56:57], v42 offset:28672
    s_waitcnt lgkmcnt(14)
    ds_read_b64_tr_b16 v[58:59], v42 offset:29184
    v_fma_f32 v158, v158, v29, -v28
    s_waitcnt lgkmcnt(14)
    ds_read_b64_tr_b16 v[60:61], v43 offset:28672
    s_waitcnt lgkmcnt(14)
    ds_read_b64_tr_b16 v[62:63], v43 offset:29184
    v_fma_f32 v159, v159, v29, -v28
    s_waitcnt lgkmcnt(0)
    s_cmp_lg_u32 s41, 0
    s_cbranch_scc1 L_ho_10
    s_mov_b32 s62, 60000
    s_mov_b64 exec, 0xff
L_hop_12:
    buffer_load_dword v2, v15, s[28:31], s63 offen sc1
    s_waitcnt vmcnt(0)
    v_cmp_ne_u32 vcc, s57, v2
    s_cbranch_vccz L_hod_13
    s_sub_u32 s62, s62, 1
    s_cbranch_scc0 L_hop_12
L_hod_13:
    s_mov_b64 exec, -1
L_ho_10:
    s_barrier
    buffer_load_dwordx4 v[192:195], v44, s[28:31], s66 offen sc1
    buffer_load_dwordx4 v[196:199], v45, s[28:31], s66 offen sc1
    buffer_load_dwordx4 v[200:203], v46, s[28:31], s66 offen sc1
    buffer_load_dwordx4 v[204:207], v47, s[28:31], s66 offen sc1
    s_add_u32 s66, s66, 16384
    buffer_load_dwordx4 v[208:211], v44, s[28:31], s66 offen sc1
    buffer_load_dwordx4 v[212:215], v45, s[28:31], s66 offen sc1
    buffer_load_dwordx4 v[216:219], v46, s[28:31], s66 offen sc1
    buffer_load_dwordx4 v[220:223], v47, s[28:31], s66 offen sc1
    s_add_u32 s66, s66, 16384
    buffer_load_dwordx4 v[224:227], v44, s[28:31], s66 offen sc1
    buffer_load_dwordx4 v[228:231], v45, s[28:31], s66 offen sc1
    buffer_load_dwordx4 v[232:235], v46, s[28:31], s66 offen sc1
    buffer_load_dwordx4 v[236:239], v47, s[28:31], s66 offen sc1
    s_add_u32 s66, s66, 16384
    buffer_load_dwordx4 v[240:243], v44, s[28:31], s66 offen sc1
    buffer_load_dwordx4 v[244:247], v45, s[28:31], s66 offen sc1
    buffer_load_dwordx4 v[248:251], v46, s[28:31], s66 offen sc1
    buffer_load_dwordx4 v[252:255], v47, s[28:31], s66 offen sc1
    s_waitcnt vmcnt(15)
    v_mfma_f32_16x16x32_bf16 v[144:147], v[176:179], v[192:195], v[144:147]
    v_mfma_f32_16x16x32_bf16 v[148:151], v[180:183], v[192:195], v[148:151]
    ds_read_b64_tr_b16 v[176:177], v40 offset:32768
    ds_read_b64_tr_b16 v[178:179], v40 offset:33280
    v_mfma_f32_16x16x32_bf16 v[152:155], v[184:187], v[192:195], v[152:155]
    ds_read_b64_tr_b16 v[180:181], v41 offset:32768
    ds_read_b64_tr_b16 v[182:183], v41 offset:33280
    v_mfma_f32_16x16x32_bf16 v[156:159], v[188:191], v[192:195], v[156:159]
    ds_read_b64_tr_b16 v[184:185], v42 offset:32768
    ds_read_b64_tr_b16 v[186:187], v42 offset:33280
    ds_read_b64_tr_b16 v[188:189], v43 offset:32768
    ds_read_b64_tr_b16 v[190:191], v43 offset:33280
    s_waitcnt vmcnt(14)
    v_mfma_f32_16x16x32_bf16 v[144:147], v[160:163], v[196:199], v[144:147]
    v_mfma_f32_16x16x32_bf16 v[148:151], v[164:167], v[196:199], v[148:151]
    ds_read_b64_tr_b16 v[160:161], v40 offset:36864
    ds_read_b64_tr_b16 v[162:163], v40 offset:37376
    v_mfma_f32_16x16x32_bf16 v[152:155], v[168:171], v[196:199], v[152:155]
    ds_read_b64_tr_b16 v[164:165], v41 offset:36864
    ds_read_b64_tr_b16 v[166:167], v41 offset:37376
    v_mfma_f32_16x16x32_bf16 v[156:159], v[172:175], v[196:199], v[156:159]
    ds_read_b64_tr_b16 v[168:169], v42 offset:36864
    ds_read_b64_tr_b16 v[170:171], v42 offset:37376
    ds_read_b64_tr_b16 v[172:173], v43 offset:36864
    s_waitcnt lgkmcnt(14)
    ds_read_b64_tr_b16 v[174:175], v43 offset:37376
    s_waitcnt vmcnt(13)
    v_mfma_f32_16x16x32_bf16 v[144:147], v[128:131], v[200:203], v[144:147]
    v_mfma_f32_16x16x32_bf16 v[148:151], v[132:135], v[200:203], v[148:151]
    s_waitcnt lgkmcnt(14)
    ds_read_b64_tr_b16 v[128:129], v40 offset:40960
    s_waitcnt lgkmcnt(14)
    ds_read_b64_tr_b16 v[130:131], v40 offset:41472
    v_mfma_f32_16x16x32_bf16 v[152:155], v[136:139], v[200:203], v[152:155]
    s_waitcnt lgkmcnt(14)
    ds_read_b64_tr_b16 v[132:133], v41 offset:40960
    s_waitcnt lgkmcnt(14)
    ds_read_b64_tr_b16 v[134:135], v41 offset:41472
    v_mfma_f32_16x16x32_bf16 v[156:159], v[140:143], v[200:203], v[156:159]
    s_waitcnt lgkmcnt(14)
    ds_read_b64_tr_b16 v[136:137], v42 offset:40960
    s_waitcnt lgkmcnt(14)
    ds_read_b64_tr_b16 v[138:139], v42 offset:41472
    s_waitcnt lgkmcnt(14)
    ds_read_b64_tr_b16 v[140:141], v43 offset:40960
    s_waitcnt lgkmcnt(14)
    ds_read_b64_tr_b16 v[142:143], v43 offset:41472
    s_waitcnt vmcnt(12)
    v_mfma_f32_16x16x32_bf16 v[144:147], v[112:115], v[204:207], v[144:147]
    v_mfma_f32_16x16x32_bf16 v[148:151], v[116:119], v[204:207], v[148:151]
    s_waitcnt lgkmcnt(14)
    ds_read_b64_tr_b16 v[112:113], v40 offset:45056
    s_waitcnt lgkmcnt(14)
    ds_read_b64_tr_b16 v[114:115], v40 offset:45568
    v_mfma_f32_16x16x32_bf16 v[152:155], v[120:123], v[204:207], v[152:155]
    s_waitcnt lgkmcnt(14)
    ds_read_b64_tr_b16 v[116:117], v41 offset:45056
    s_waitcnt lgkmcnt(14)
    ds_read_b64_tr_b16 v[118:119], v41 offset:45568
    v_mfma_f32_16x16x32_bf16 v[156:159], v[124:127], v[204:207], v[156:159]
    s_waitcnt lgkmcnt(14)
    ds_read_b64_tr_b16 v[120:121], v42 offset:45056
    s_waitcnt lgkmcnt(14)
    ds_read_b64_tr_b16 v[122:123], v42 offset:45568
    s_waitcnt lgkmcnt(14)
    ds_read_b64_tr_b16 v[124:125], v43 offset:45056
    s_waitcnt lgkmcnt(14)
    ds_read_b64_tr_b16 v[126:127], v43 offset:45568
    s_waitcnt vmcnt(11)
    v_mfma_f32_16x16x32_bf16 v[144:147], v[96:99], v[208:211], v[144:147]
    v_mfma_f32_16x16x32_bf16 v[148:151], v[100:103], v[208:211], v[148:151]
    s_waitcnt lgkmcnt(14)
    ds_read_b64_tr_b16 v[96:97], v40 offset:49152
    s_waitcnt lgkmcnt(14)
    ds_read_b64_tr_b16 v[98:99], v40 offset:49664
    v_mfma_f32_16x16x32_bf16 v[152:155], v[104:107], v[208:211], v[152:155]
    s_waitcnt lgkmcnt(14)
    ds_read_b64_tr_b16 v[100:101], v41 offset:49152
    s_waitcnt lgkmcnt(14)
    ds_read_b64_tr_b16 v[102:103], v41 offset:49664
    v_mfma_f32_16x16x32_bf16 v[156:159], v[108:111], v[208:211], v[156:159]
    s_waitcnt lgkmcnt(14)
    ds_read_b64_tr_b16 v[104:105], v42 offset:49152
    s_waitcnt lgkmcnt(14)
    ds_read_b64_tr_b16 v[106:107], v42 offset:49664
    s_waitcnt lgkmcnt(14)
    ds_read_b64_tr_b16 v[108:109], v43 offset:49152
    s_waitcnt lgkmcnt(14)
    ds_read_b64_tr_b16 v[110:111], v43 offset:49664
    s_waitcnt vmcnt(10)
    v_mfma_f32_16x16x32_bf16 v[144:147], v[80:83], v[212:215], v[144:147]
    v_mfma_f32_16x16x32_bf16 v[148:151], v[84:87], v[212:215], v[148:151]
    s_waitcnt lgkmcnt(14)
    ds_read_b64_tr_b16 v[80:81], v40 offset:53248
    s_waitcnt lgkmcnt(14)
    ds_read_b64_tr_b16 v[82:83], v40 offset:53760
    v_mfma_f32_16x16x32_bf16 v[152:155], v[88:91], v[212:215], v[152:155]
    s_waitcnt lgkmcnt(14)
    ds_read_b64_tr_b16 v[84:85], v41 offset:53248
    s_waitcnt lgkmcnt(14)
    ds_read_b64_tr_b16 v[86:87], v41 offset:53760
    v_mfma_f32_16x16x32_bf16 v[156:159], v[92:95], v[212:215], v[156:159]
    s_waitcnt lgkmcnt(14)
    ds_read_b64_tr_b16 v[88:89], v42 offset:53248
    s_waitcnt lgkmcnt(14)
    ds_read_b64_tr_b16 v[90:91], v42 offset:53760
    s_waitcnt lgkmcnt(14)
    ds_read_b64_tr_b16 v[92:93], v43 offset:53248
    s_waitcnt lgkmcnt(14)
    ds_read_b64_tr_b16 v[94:95], v43 offset:53760
    s_waitcnt vmcnt(9)
    v_mfma_f32_16x16x32_bf16 v[144:147], v[64:67], v[216:219], v[144:147]
    v_mfma_f32_16x16x32_bf16 v[148:151], v[68:71], v[216:219], v[148:151]
    s_waitcnt lgkmcnt(14)
    ds_read_b64_tr_b16 v[64:65], v40 offset:57344
    s_waitcnt lgkmcnt(14)
    ds_read_b64_tr_b16 v[66:67], v40 offset:57856
    v_mfma_f32_16x16x32_bf16 v[152:155], v[72:75], v[216:219], v[152:155]
    s_waitcnt lgkmcnt(14)
    ds_read_b64_tr_b16 v[68:69], v41 offset:57344
    s_waitcnt lgkmcnt(14)
    ds_read_b64_tr_b16 v[70:71], v41 offset:57856
    v_mfma_f32_16x16x32_bf16 v[156:159], v[76:79], v[216:219], v[156:159]
    s_waitcnt lgkmcnt(14)
    ds_read_b64_tr_b16 v[72:73], v42 offset:57344
    s_waitcnt lgkmcnt(14)
    ds_read_b64_tr_b16 v[74:75], v42 offset:57856
    s_waitcnt lgkmcnt(14)
    ds_read_b64_tr_b16 v[76:77], v43 offset:57344
    s_waitcnt lgkmcnt(14)
    ds_read_b64_tr_b16 v[78:79], v43 offset:57856
    s_waitcnt vmcnt(8)
    v_mfma_f32_16x16x32_bf16 v[144:147], v[48:51], v[220:223], v[144:147]
    v_mfma_f32_16x16x32_bf16 v[148:151], v[52:55], v[220:223], v[148:151]
    s_waitcnt lgkmcnt(14)
    ds_read_b64_tr_b16 v[48:49], v40 offset:61440
    s_waitcnt lgkmcnt(14)
    ds_read_b64_tr_b16 v[50:51], v40 offset:61952
    v_mfma_f32_16x16x32_bf16 v[152:155], v[56:59], v[220:223], v[152:155]
    s_waitcnt lgkmcnt(14)
    ds_read_b64_tr_b16 v[52:53], v41 offset:61440
    s_waitcnt lgkmcnt(14)
    ds_read_b64_tr_b16 v[54:55], v41 offset:61952
    v_mfma_f32_16x16x32_bf16 v[156:159], v[60:63], v[220:223], v[156:159]
    s_waitcnt lgkmcnt(14)
    ds_read_b64_tr_b16 v[56:57], v42 offset:61440
    s_waitcnt lgkmcnt(14)
    ds_read_b64_tr_b16 v[58:59], v42 offset:61952
    s_waitcnt lgkmcnt(14)
    ds_read_b64_tr_b16 v[60:61], v43 offset:61440
    s_waitcnt lgkmcnt(14)
    ds_read_b64_tr_b16 v[62:63], v43 offset:61952
    s_waitcnt vmcnt(7) lgkmcnt(15)
    v_mfma_f32_16x16x32_bf16 v[144:147], v[176:179], v[224:227], v[144:147]
    v_mfma_f32_16x16x32_bf16 v[148:151], v[180:183], v[224:227], v[148:151]
    v_mfma_f32_16x16x32_bf16 v[152:155], v[184:187], v[224:227], v[152:155]
    v_mfma_f32_16x16x32_bf16 v[156:159], v[188:191], v[224:227], v[156:159]
    s_waitcnt vmcnt(6) lgkmcnt(15)
    v_mfma_f32_16x16x32_bf16 v[144:147], v[160:163], v[228:231], v[144:147]
    v_mfma_f32_16x16x32_bf16 v[148:151], v[164:167], v[228:231], v[148:151]
    v_mfma_f32_16x16x32_bf16 v[152:155], v[168:171], v[228:231], v[152:155]
    v_mfma_f32_16x16x32_bf16 v[156:159], v[172:175], v[228:231], v[156:159]
    s_waitcnt vmcnt(5) lgkmcnt(15)
    v_mfma_f32_16x16x32_bf16 v[144:147], v[128:131], v[232:235], v[144:147]
    v_mfma_f32_16x16x32_bf16 v[148:151], v[132:135], v[232:235], v[148:151]
    v_mfma_f32_16x16x32_bf16 v[152:155], v[136:139], v[232:235], v[152:155]
    v_mfma_f32_16x16x32_bf16 v[156:159], v[140:143], v[232:235], v[156:159]
    s_waitcnt vmcnt(4) lgkmcnt(15)
    v_mfma_f32_16x16x32_bf16 v[144:147], v[112:115], v[236:239], v[144:147]
    v_mfma_f32_16x16x32_bf16 v[148:151], v[116:119], v[236:239], v[148:151]
    v_mfma_f32_16x16x32_bf16 v[152:155], v[120:123], v[236:239], v[152:155]
    v_mfma_f32_16x16x32_bf16 v[156:159], v[124:127], v[236:239], v[156:159]
    s_waitcnt vmcnt(3) lgkmcnt(15)
    v_mfma_f32_16x16x32_bf16 v[144:147], v[96:99], v[240:243], v[144:147]
    v_mfma_f32_16x16x32_bf16 v[148:151], v[100:103], v[240:243], v[148:151]
    v_mfma_f32_16x16x32_bf16 v[152:155], v[104:107], v[240:243], v[152:155]
    v_mfma_f32_16x16x32_bf16 v[156:159], v[108:111], v[240:243], v[156:159]
    s_waitcnt vmcnt(2) lgkmcnt(15)
    v_mfma_f32_16x16x32_bf16 v[144:147], v[80:83], v[244:247], v[144:147]
    v_mfma_f32_16x16x32_bf16 v[148:151], v[84:87], v[244:247], v[148:151]
    v_mfma_f32_16x16x32_bf16 v[152:155], v[88:91], v[244:247], v[152:155]
    v_mfma_f32_16x16x32_bf16 v[156:159], v[92:95], v[244:247], v[156:159]
    s_waitcnt vmcnt(1) lgkmcnt(8)
    v_mfma_f32_16x16x32_bf16 v[144:147], v[64:67], v[248:251], v[144:147]
    v_mfma_f32_16x16x32_bf16 v[148:151], v[68:71], v[248:251], v[148:151]
    v_mfma_f32_16x16x32_bf16 v[152:155], v[72:75], v[248:251], v[152:155]
    v_mfma_f32_16x16x32_bf16 v[156:159], v[76:79], v[248:251], v[156:159]
    s_waitcnt vmcnt(0) lgkmcnt(0)
    v_mfma_f32_16x16x32_bf16 v[144:147], v[48:51], v[252:255], v[144:147]
    v_mfma_f32_16x16x32_bf16 v[148:151], v[52:55], v[252:255], v[148:151]
    v_mfma_f32_16x16x32_bf16 v[152:155], v[56:59], v[252:255], v[152:155]
    v_mfma_f32_16x16x32_bf16 v[156:159], v[60:63], v[252:255], v[156:159]
    s_nop 4
    v_cvt_pk_bf16_f32 v32, v144, v145
    v_cvt_pk_bf16_f32 v33, v146, v147
    v_cvt_pk_bf16_f32 v34, v148, v149
    v_cvt_pk_bf16_f32 v35, v150, v151
    v_cvt_pk_bf16_f32 v36, v152, v153
    v_cvt_pk_bf16_f32 v37, v154, v155
    v_cvt_pk_bf16_f32 v38, v156, v157
    v_cvt_pk_bf16_f32 v39, v158, v159
    v_permlane16_swap_b32 v32, v34
    v_permlane16_swap_b32 v33, v35
    v_permlane16_swap_b32 v36, v38
    v_permlane16_swap_b32 v37, v39
    buffer_store_dwordx4 v[32:35], v17, s[28:31], s60 offen sc1
    buffer_store_dwordx4 v[36:39], v17, s[28:31], s61 offen sc1
    v_pk_add_f32 v[28:29], v[144:145], v[146:147]
    v_pk_mul_f32 v[30:31], v[144:145], v[144:145]
    v_pk_fma_f32 v[30:31], v[146:147], v[146:147], v[30:31]
    v_pk_add_f32 v[28:29], v[28:29], v[148:149]
    v_pk_fma_f32 v[30:31], v[148:149], v[148:149], v[30:31]
    v_pk_add_f32 v[28:29], v[28:29], v[150:151]
    v_pk_fma_f32 v[30:31], v[150:151], v[150:151], v[30:31]
    v_pk_add_f32 v[28:29], v[28:29], v[152:153]
    v_pk_fma_f32 v[30:31], v[152:153], v[152:153], v[30:31]
    v_pk_add_f32 v[28:29], v[28:29], v[154:155]
    v_pk_fma_f32 v[30:31], v[154:155], v[154:155], v[30:31]
    v_pk_add_f32 v[28:29], v[28:29], v[156:157]
    v_pk_fma_f32 v[30:31], v[156:157], v[156:157], v[30:31]
    v_pk_add_f32 v[28:29], v[28:29], v[158:159]
    v_pk_fma_f32 v[30:31], v[158:159], v[158:159], v[30:31]
    v_add_f32 v28, v28, v29
    v_add_f32 v29, v30, v31
    v_mov_b32 v30, v28
    v_mov_b32 v31, v29
    s_lshl_b32 s50, s42, 3
    s_add_u32 s50, s50, s43
    v_permlane32_swap_b32 v28, v30
    v_permlane32_swap_b32 v29, v31
    v_pk_add_f32 v[28:29], v[28:29], v[30:31]
    v_lshlrev_b32 v1, 3, v0
    v_mov_b32 v30, v28
    v_mov_b32 v31, v29
    s_lshl_b32 s50, s50, 9
    s_lshl_b32 s51, s41, 7
    v_permlane16_swap_b32 v28, v30
    v_permlane16_swap_b32 v29, v31
    s_add_u32 s50, s50, s51
    s_add_u32 s50, s50, 65536
    v_pk_add_f32 v[28:29], v[28:29], v[30:31]
    s_mov_b64 exec, 0xffff
    buffer_store_dwordx2 v[28:29], v1, s[28:31], s50 offen sc1
    s_mov_b64 exec, -1
    v_and_b32 v1, 1, v0
    v_lshlrev_b32 v1, 5, v1
    v_bfe_u32 v2, v0, 1, 1
    v_lshl_add_u32 v1, v2, 3, v1
    v_and_b32 v2, 1, v9
    v_lshl_add_u32 v1, v2, 4, v1
    v_add_u32 v1, v1, v10
    v_lshrrev_b32 v3, 5, v0
    v_lshl_add_u32 v11, v3, 10, v1
    v_lshl_add_u32 v40, v3, 9, v1
    v_add_u32 v41, 65536, v11
    v_lshlrev_b32 v42, 6, v3
    v_add_u32 v42, 163328, v42
    s_lshl_b32 s50, s47, 5
    v_and_b32 v1, 31, v0
    v_add_u32 v1, s50, v1
    v_lshlrev_b32 v2, 4, v1
    v_lshl_add_u32 v44, v3, 10, v2
    v_add_u32 v45, 4096, v44
    v_add_u32 v46, 8192, v44
    v_add_u32 v47, 12288, v44
    v_lshl_add_u32 v19, v3, 11, v2
    v_lshlrev_b32 v1, 3, v1
    v_lshl_add_u32 v6, v3, 11, v1
    s_lshl_b32 s50, s45, 1
    s_add_u32 s50, s50, s48
    s_lshl_b32 s66, s50, 16
    s_add_u32 s66, s66, 3145728
    s_mul_i32 s67, s50, 176128
    s_lshl_b32 s70, s50, 12
    s_add_u32 s70, s70, 65536
    s_add_u32 s67, s67, 5242880
    s_cmp_lt_u32 s46, 11
    s_cselect_b32 s51, 0, 268435456
    v_add_u32 v17, s51, v19
    s_min_u32 s50, s46, 10
    s_lshl_b32 s50, s50, 12
    s_add_u32 s68, s67, s50
    s_add_u32 s68, s68, 131072
    s_lshl_b32 s50, s46, 13
    s_add_u32 s67, s67, s50
    s_lshl_b32 s63, s45, 7
    s_add_u32 s63, s63, 8192
    s_lshl_b32 s65, s46, 2
    s_add_u32 s65, s65, s63
    s_waitcnt vmcnt(0)
    s_barrier
    ds_read_b64_tr_b16 v[48:49], v41 offset:0
    ds_read_b64_tr_b16 v[50:51], v41 offset:512
    ds_read_b64_tr_b16 v[52:53], v41 offset:256
    ds_read_b64_tr_b16 v[54:55], v41 offset:768
    ds_read_b64_tr_b16 v[32:33], v40 offset:0
    ds_read_b64_tr_b16 v[34:35], v40 offset:256
    ds_read_b64_tr_b16 v[56:57], v41 offset:2048
    ds_read_b64_tr_b16 v[58:59], v41 offset:2560
    ds_read_b64_tr_b16 v[60:61], v41 offset:2304
    ds_read_b64_tr_b16 v[62:63], v41 offset:2816
    ds_read_b64_tr_b16 v[36:37], v40 offset:1024
    ds_read_b64_tr_b16 v[38:39], v40 offset:1280
    ds_read_b64_tr_b16 v[64:65], v41 offset:4096
    ds_read_b64_tr_b16 v[66:67], v41 offset:4608
    ds_read_b64_tr_b16 v[68:69], v41 offset:4352
    s_waitcnt lgkmcnt(14)
    ds_read_b64_tr_b16 v[70:71], v41 offset:4864
    s_cmp_lg_u32 s41, 0
    s_cbranch_scc1 L_ho_14
    s_mov_b64 exec, 1
    s_cmp_eq_u32 s64, 0
    s_cbranch_scc1 L_hof_15
    buffer_store_dword v13, v15, s[28:31], s65 offen
    s_branch L_hop_16_a
L_hof_15:
    buffer_store_dword v13, v15, s[28:31], s65 offen sc1
L_hop_16_a:
    s_mov_b32 s62, 60000
    s_mov_b64 exec, 0xffff
L_hop_16:
    buffer_load_dword v2, v15, s[28:31], s63 offen sc1
    s_waitcnt vmcnt(0)
    v_cmp_ne_u32 vcc, s57, v2
    s_cbranch_vccz L_hod_17
    s_sub_u32 s62, s62, 1
    s_cbranch_scc0 L_hop_16
L_hod_17:
    s_mov_b64 exec, -1
L_ho_14:
    s_barrier
    buffer_load_dwordx4 v[128:131], v44, s[28:31], s66 offen offset:0 sc1
    buffer_load_dwordx4 v[132:135], v44, s[28:31], s66 offen offset:2048 sc1
    buffer_load_dwordx4 v[136:139], v45, s[28:31], s66 offen offset:0 sc1
    buffer_load_dwordx4 v[140:143], v45, s[28:31], s66 offen offset:2048 sc1
    buffer_load_dwordx4 v[144:147], v46, s[28:31], s66 offen offset:0 sc1
    buffer_load_dwordx4 v[148:151], v46, s[28:31], s66 offen offset:2048 sc1
    buffer_load_dwordx4 v[152:155], v47, s[28:31], s66 offen offset:0 sc1
    buffer_load_dwordx4 v[156:159], v47, s[28:31], s66 offen offset:2048 sc1
    s_add_u32 s66, s66, 16384
    buffer_load_dwordx4 v[160:163], v44, s[28:31], s66 offen offset:0 sc1
    buffer_load_dwordx4 v[164:167], v44, s[28:31], s66 offen offset:2048 sc1
    buffer_load_dwordx4 v[168:171], v45, s[28:31], s66 offen offset:0 sc1
    buffer_load_dwordx4 v[172:175], v45, s[28:31], s66 offen offset:2048 sc1
    s_waitcnt vmcnt(11) lgkmcnt(10)
    v_mfma_f32_32x32x16_bf16 v[96:111], v[48:51], v[128:131], 0
    ds_read_b64_tr_b16 v[72:73], v41 offset:6144
    ds_read_b64_tr_b16 v[74:75], v41 offset:6656
    buffer_load_dwordx4 v[176:179], v46, s[28:31], s66 offen offset:0 sc1
    v_mfma_f32_32x32x16_bf16 v[112:127], v[52:55], v[128:131], 0
    ds_read_b64_tr_b16 v[76:77], v41 offset:6400
    ds_read_b64_tr_b16 v[78:79], v41 offset:6912
    buffer_load_dwordx4 v[180:183], v46, s[28:31], s66 offen offset:2048 sc1
    v_mfma_f32_32x32x16_bf16 v[80:95], v[32:35], v[128:131], 0
    ds_read_b64_tr_b16 v[32:33], v40 offset:2048
    s_waitcnt lgkmcnt(14)
    ds_read_b64_tr_b16 v[34:35], v40 offset:2304
    s_waitcnt vmcnt(12) lgkmcnt(10)
    v_mfma_f32_32x32x16_bf16 v[96:111], v[56:59], v[132:135], v[96:111]
    ds_read_b64_tr_b16 v[48:49], v41 offset:8192
    ds_read_b64_tr_b16 v[50:51], v41 offset:8704
    buffer_load_dwordx4 v[184:187], v47, s[28:31], s66 offen offset:0 sc1
    v_mfma_f32_32x32x16_bf16 v[112:127], v[60:63], v[132:135], v[112:127]
    ds_read_b64_tr_b16 v[52:53], v41 offset:8448
    ds_read_b64_tr_b16 v[54:55], v41 offset:8960
    buffer_load_dwordx4 v[188:191], v47, s[28:31], s66 offen offset:2048 sc1
    v_mfma_f32_32x32x16_bf16 v[80:95], v[36:39], v[132:135], v[80:95]
    ds_read_b64_tr_b16 v[36:37], v40 offset:3072
    s_waitcnt lgkmcnt(14)
    ds_read_b64_tr_b16 v[38:39], v40 offset:3328
    s_waitcnt vmcnt(13) lgkmcnt(6)
    v_mfma_f32_32x32x16_bf16 v[96:111], v[64:67], v[136:139], v[96:111]
    ds_read_b64_tr_b16 v[56:57], v41 offset:10240
    ds_read_b64_tr_b16 v[58:59], v41 offset:10752
    s_add_u32 s66, s66, 16384
    buffer_load_dwordx4 v[192:195], v44, s[28:31], s66 offen offset:0 sc1
    v_mfma_f32_32x32x16_bf16 v[112:127], v[68:71], v[136:139], v[112:127]
    ds_read_b64_tr_b16 v[60:61], v41 offset:10496
    ds_read_b64_tr_b16 v[62:63], v41 offset:11008
    buffer_load_dwordx4 v[196:199], v44, s[28:31], s66 offen offset:2048 sc1
    v_mfma_f32_32x32x16_bf16 v[80:95], v[32:35], v[136:139], v[80:95]
    ds_read_b64_tr_b16 v[32:33], v40 offset:4096
    ds_read_b64_tr_b16 v[34:35], v40 offset:4352
    s_waitcnt vmcnt(14) lgkmcnt(6)
    v_mfma_f32_32x32x16_bf16 v[96:111], v[72:75], v[140:143], v[96:111]
    ds_read_b64_tr_b16 v[64:65], v41 offset:12288
    ds_read_b64_tr_b16 v[66:67], v41 offset:12800
    buffer_load_dwordx4 v[200:203], v45, s[28:31], s66 offen offset:0 sc1
    v_mfma_f32_32x32x16_bf16 v[112:127], v[76:79], v[140:143], v[112:127]
    ds_read_b64_tr_b16 v[68:69], v41 offset:12544
    ds_read_b64_tr_b16 v[70:71], v41 offset:13056
    buffer_load_dwordx4 v[204:207], v45, s[28:31], s66 offen offset:2048 sc1
    v_mfma_f32_32x32x16_bf16 v[80:95], v[36:39], v[140:143], v[80:95]
    ds_read_b64_tr_b16 v[36:37], v40 offset:5120
    ds_read_b64_tr_b16 v[38:39], v40 offset:5376
    s_waitcnt vmcnt(15) lgkmcnt(6)
    v_mfma_f32_32x32x16_bf16 v[96:111], v[48:51], v[144:147], v[96:111]
    ds_read_b64_tr_b16 v[72:73], v41 offset:14336
    ds_read_b64_tr_b16 v[74:75], v41 offset:14848
    buffer_load_dwordx4 v[208:211], v46, s[28:31], s66 offen offset:0 sc1
    v_mfma_f32_32x32x16_bf16 v[112:127], v[52:55], v[144:147], v[112:127]
    ds_read_b64_tr_b16 v[76:77], v41 offset:14592
    ds_read_b64_tr_b16 v[78:79], v41 offset:15104
    buffer_load_dwordx4 v[212:215], v46, s[28:31], s66 offen offset:2048 sc1
    v_mfma_f32_32x32x16_bf16 v[80:95], v[32:35], v[144:147], v[80:95]
    ds_read_b64_tr_b16 v[32:33], v40 offset:6144
    ds_read_b64_tr_b16 v[34:35], v40 offset:6400
    s_waitcnt vmcnt(16) lgkmcnt(6)
    v_mfma_f32_32x32x16_bf16 v[96:111], v[56:59], v[148:151], v[96:111]
    ds_read_b64_tr_b16 v[48:49], v41 offset:16384
    ds_read_b64_tr_b16 v[50:51], v41 offset:16896
    buffer_load_dwordx4 v[216:219], v47, s[28:31], s66 offen offset:0 sc1
    v_mfma_f32_32x32x16_bf16 v[112:127], v[60:63], v[148:151], v[112:127]
    ds_read_b64_tr_b16 v[52:53], v41 offset:16640
    ds_read_b64_tr_b16 v[54:55], v41 offset:17152
    buffer_load_dwordx4 v[220:223], v47, s[28:31], s66 offen offset:2048 sc1
    v_mfma_f32_32x32x16_bf16 v[80:95], v[36:39], v[148:151], v[80:95]
    ds_read_b64_tr_b16 v[36:37], v40 offset:7168
    ds_read_b64_tr_b16 v[38:39], v40 offset:7424
    s_waitcnt vmcnt(17) lgkmcnt(6)
    v_mfma_f32_32x32x16_bf16 v[96:111], v[64:67], v[152:155], v[96:111]
    ds_read_b64_tr_b16 v[56:57], v41 offset:18432
    ds_read_b64_tr_b16 v[58:59], v41 offset:18944
    s_add_u32 s66, s66, 16384
    buffer_load_dwordx4 v[224:227], v44, s[28:31], s66 offen offset:0 sc1
    v_mfma_f32_32x32x16_bf16 v[112:127], v[68:71], v[152:155], v[112:127]
    ds_read_b64_tr_b16 v[60:61], v41 offset:18688
    ds_read_b64_tr_b16 v[62:63], v41 offset:19200
    v_mfma_f32_32x32x16_bf16 v[80:95], v[32:35], v[152:155], v[80:95]
    s_waitcnt vmcnt(17) lgkmcnt(4)
    v_mfma_f32_32x32x16_bf16 v[96:111], v[72:75], v[156:159], v[96:111]
    ds_read_b64_tr_b16 v[64:65], v41 offset:20480
    ds_read_b64_tr_b16 v[66:67], v41 offset:20992
    buffer_load_dwordx4 v[228:231], v44, s[28:31], s66 offen offset:2048 sc1
    v_mfma_f32_32x32x16_bf16 v[112:127], v[76:79], v[156:159], v[112:127]
    ds_read_b64_tr_b16 v[68:69], v41 offset:20736
    ds_read_b64_tr_b16 v[70:71], v41 offset:21248
    v_mfma_f32_32x32x16_bf16 v[80:95], v[36:39], v[156:159], v[80:95]
    s_waitcnt vmcnt(17) lgkmcnt(10)
    v_mfma_f32_32x32x16_bf16 v[96:111], v[48:51], v[160:163], v[96:111]
    ds_read_b64_tr_b16 v[72:73], v41 offset:22528
    ds_read_b64_tr_b16 v[74:75], v41 offset:23040
    buffer_load_dwordx4 v[232:235], v45, s[28:31], s66 offen offset:0 sc1
    v_mfma_f32_32x32x16_bf16 v[112:127], v[52:55], v[160:163], v[112:127]
    ds_read_b64_tr_b16 v[76:77], v41 offset:22784
    ds_read_b64_tr_b16 v[78:79], v41 offset:23296
    s_waitcnt vmcnt(17) lgkmcnt(8)
    v_mfma_f32_32x32x16_bf16 v[96:111], v[56:59], v[164:167], v[96:111]
    ds_read_b64_tr_b16 v[48:49], v41 offset:24576
    ds_read_b64_tr_b16 v[50:51], v41 offset:25088
    buffer_load_dwordx4 v[236:239], v45, s[28:31], s66 offen offset:2048 sc1
    v_mfma_f32_32x32x16_bf16 v[112:127], v[60:63], v[164:167], v[112:127]
    ds_read_b64_tr_b16 v[52:53], v41 offset:24832
    ds_read_b64_tr_b16 v[54:55], v41 offset:25344
    s_waitcnt vmcnt(17) lgkmcnt(8)
    v_mfma_f32_32x32x16_bf16 v[96:111], v[64:67], v[168:171], v[96:111]
    ds_read_b64_tr_b16 v[56:57], v41 offset:26624
    ds_read_b64_tr_b16 v[58:59], v41 offset:27136
    buffer_load_dwordx4 v[240:243], v46, s[28:31], s66 offen offset:0 sc1
    v_mfma_f32_32x32x16_bf16 v[112:127], v[68:71], v[168:171], v[112:127]
    ds_read_b64_tr_b16 v[60:61], v41 offset:26880
    ds_read_b64_tr_b16 v[62:63], v41 offset:27392
    s_waitcnt vmcnt(17) lgkmcnt(8)
    v_mfma_f32_32x32x16_bf16 v[96:111], v[72:75], v[172:175], v[96:111]
    ds_read_b64_tr_b16 v[64:65], v41 offset:28672
    ds_read_b64_tr_b16 v[66:67], v41 offset:29184
    buffer_load_dwordx4 v[244:247], v46, s[28:31], s66 offen offset:2048 sc1
    v_mfma_f32_32x32x16_bf16 v[112:127], v[76:79], v[172:175], v[112:127]
    ds_read_b64_tr_b16 v[68:69], v41 offset:28928
    ds_read_b64_tr_b16 v[70:71], v41 offset:29440
    s_waitcnt vmcnt(17) lgkmcnt(8)
    v_mfma_f32_32x32x16_bf16 v[96:111], v[48:51], v[176:179], v[96:111]
    ds_read_b64_tr_b16 v[72:73], v41 offset:30720
    ds_read_b64_tr_b16 v[74:75], v41 offset:31232
    buffer_load_dwordx4 v[248:251], v47, s[28:31], s66 offen offset:0 sc1
    v_mfma_f32_32x32x16_bf16 v[112:127], v[52:55], v[176:179], v[112:127]
    ds_read_b64_tr_b16 v[76:77], v41 offset:30976
    ds_read_b64_tr_b16 v[78:79], v41 offset:31488
    s_waitcnt vmcnt(17) lgkmcnt(8)
    v_mfma_f32_32x32x16_bf16 v[96:111], v[56:59], v[180:183], v[96:111]
    ds_read_b64_tr_b16 v[48:49], v41 offset:32768
    ds_read_b64_tr_b16 v[50:51], v41 offset:33280
    buffer_load_dwordx4 v[252:255], v47, s[28:31], s66 offen offset:2048 sc1
    buffer_load_dwordx2 v[128:129], v6, s[28:31], s70 offen offset:0 sc1
    buffer_load_dwordx2 v[130:131], v6, s[28:31], s70 offen offset:512 sc1
    buffer_load_dwordx2 v[132:133], v6, s[28:31], s70 offen offset:1024 sc1
    buffer_load_dwordx2 v[134:135], v6, s[28:31], s70 offen offset:1536 sc1
    s_barrier
    v_mfma_f32_32x32x16_bf16 v[112:127], v[60:63], v[180:183], v[112:127]
    ds_read_b64_tr_b16 v[52:53], v41 offset:33024
    ds_read_b64_tr_b16 v[54:55], v41 offset:33536
    s_waitcnt vmcnt(21) lgkmcnt(8)
    v_mfma_f32_32x32x16_bf16 v[96:111], v[64:67], v[184:187], v[96:111]
    ds_read_b64_tr_b16 v[56:57], v41 offset:34816
    ds_read_b64_tr_b16 v[58:59], v41 offset:35328
    v_mfma_f32_32x32x16_bf16 v[112:127], v[68:71], v[184:187], v[112:127]
    ds_read_b64_tr_b16 v[60:61], v41 offset:35072
    ds_read_b64_tr_b16 v[62:63], v41 offset:35584
    s_waitcnt vmcnt(20) lgkmcnt(8)
    v_mfma_f32_32x32x16_bf16 v[96:111], v[72:75], v[188:191], v[96:111]
    ds_read_b64_tr_b16 v[64:65], v41 offset:36864
    ds_read_b64_tr_b16 v[66:67], v41 offset:37376
    v_mfma_f32_32x32x16_bf16 v[112:127], v[76:79], v[188:191], v[112:127]
    ds_read_b64_tr_b16 v[68:69], v41 offset:37120
    ds_read_b64_tr_b16 v[70:71], v41 offset:37632
    s_waitcnt vmcnt(19) lgkmcnt(8)
    v_mfma_f32_32x32x16_bf16 v[96:111], v[48:51], v[192:195], v[96:111]
    ds_read_b64_tr_b16 v[72:73], v41 offset:38912
    ds_read_b64_tr_b16 v[74:75], v41 offset:39424
    v_mfma_f32_32x32x16_bf16 v[112:127], v[52:55], v[192:195], v[112:127]
    ds_read_b64_tr_b16 v[76:77], v41 offset:39168
    ds_read_b64_tr_b16 v[78:79], v41 offset:39680
    s_waitcnt vmcnt(18) lgkmcnt(8)
    v_mfma_f32_32x32x16_bf16 v[96:111], v[56:59], v[196:199], v[96:111]
    ds_read_b64_tr_b16 v[48:49], v41 offset:40960
    ds_read_b64_tr_b16 v[50:51], v41 offset:41472
    v_mfma_f32_32x32x16_bf16 v[112:127], v[60:63], v[196:199], v[112:127]
    ds_read_b64_tr_b16 v[52:53], v41 offset:41216
    ds_read_b64_tr_b16 v[54:55], v41 offset:41728
    s_waitcnt vmcnt(17) lgkmcnt(8)
    v_mfma_f32_32x32x16_bf16 v[96:111], v[64:67], v[200:203], v[96:111]
    ds_read_b64_tr_b16 v[56:57], v41 offset:43008
    ds_read_b64_tr_b16 v[58:59], v41 offset:43520
    v_mfma_f32_32x32x16_bf16 v[112:127], v[68:71], v[200:203], v[112:127]
    ds_read_b64_tr_b16 v[60:61], v41 offset:43264
    ds_read_b64_tr_b16 v[62:63], v41 offset:43776
    s_waitcnt vmcnt(16) lgkmcnt(8)
    v_mfma_f32_32x32x16_bf16 v[96:111], v[72:75], v[204:207], v[96:111]
    ds_read_b64_tr_b16 v[64:65], v41 offset:45056
    ds_read_b64_tr_b16 v[66:67], v41 offset:45568
    v_mfma_f32_32x32x16_bf16 v[112:127], v[76:79], v[204:207], v[112:127]
    ds_read_b64_tr_b16 v[68:69], v41 offset:45312
    ds_read_b64_tr_b16 v[70:71], v41 offset:45824
    s_waitcnt vmcnt(15) lgkmcnt(8)
    v_mfma_f32_32x32x16_bf16 v[96:111], v[48:51], v[208:211], v[96:111]
    ds_read_b64_tr_b16 v[72:73], v41 offset:47104
    ds_read_b64_tr_b16 v[74:75], v41 offset:47616
    v_mfma_f32_32x32x16_bf16 v[112:127], v[52:55], v[208:211], v[112:127]
    ds_read_b64_tr_b16 v[76:77], v41 offset:47360
    ds_read_b64_tr_b16 v[78:79], v41 offset:47872
    s_waitcnt vmcnt(14) lgkmcnt(8)
    v_mfma_f32_32x32x16_bf16 v[96:111], v[56:59], v[212:215], v[96:111]
    ds_read_b64_tr_b16 v[48:49], v41 offset:49152
    ds_read_b64_tr_b16 v[50:51], v41 offset:49664
    s_waitcnt vmcnt(0)
    v_pk_add_f32 v[128:129], v[128:129], v[130:131]
    v_mfma_f32_32x32x16_bf16 v[112:127], v[60:63], v[212:215], v[112:127]
    ds_read_b64_tr_b16 v[52:53], v41 offset:49408
    ds_read_b64_tr_b16 v[54:55], v41 offset:49920
    s_waitcnt vmcnt(13) lgkmcnt(8)
    v_mfma_f32_32x32x16_bf16 v[96:111], v[64:67], v[216:219], v[96:111]
    ds_read_b64_tr_b16 v[56:57], v41 offset:51200
    ds_read_b64_tr_b16 v[58:59], v41 offset:51712
    v_pk_add_f32 v[132:133], v[132:133], v[134:135]
    v_pk_add_f32 v[128:129], v[128:129], v[132:133]
    v_mfma_f32_32x32x16_bf16 v[112:127], v[68:71], v[216:219], v[112:127]
    ds_read_b64_tr_b16 v[60:61], v41 offset:51456
    ds_read_b64_tr_b16 v[62:63], v41 offset:51968
    s_waitcnt vmcnt(12) lgkmcnt(8)
    v_mfma_f32_32x32x16_bf16 v[96:111], v[72:75], v[220:223], v[96:111]
    ds_read_b64_tr_b16 v[64:65], v41 offset:53248
    ds_read_b64_tr_b16 v[66:67], v41 offset:53760
    v_mov_b32 v130, v128
    v_mov_b32 v131, v129
    v_mfma_f32_32x32x16_bf16 v[112:127], v[76:79], v[220:223], v[112:127]
    ds_read_b64_tr_b16 v[68:69], v41 offset:53504
    ds_read_b64_tr_b16 v[70:71], v41 offset:54016
    s_waitcnt vmcnt(11) lgkmcnt(8)
    v_mfma_f32_32x32x16_bf16 v[96:111], v[48:51], v[224:227], v[96:111]
    ds_read_b64_tr_b16 v[72:73], v41 offset:55296
    ds_read_b64_tr_b16 v[74:75], v41 offset:55808
    v_permlane32_swap_b32 v128, v130
    v_permlane32_swap_b32 v129, v131
    v_mfma_f32_32x32x16_bf16 v[112:127], v[52:55], v[224:227], v[112:127]
    ds_read_b64_tr_b16 v[76:77], v41 offset:55552
    ds_read_b64_tr_b16 v[78:79], v41 offset:56064
    s_waitcnt vmcnt(10) lgkmcnt(8)
    v_mfma_f32_32x32x16_bf16 v[96:111], v[56:59], v[228:231], v[96:111]
    ds_read_b64_tr_b16 v[48:49], v41 offset:57344
    ds_read_b64_tr_b16 v[50:51], v41 offset:57856
    v_pk_add_f32 v[128:129], v[128:129], v[130:131]
    v_mul_f32 v128, 0x3b000000, v128
    v_mfma_f32_32x32x16_bf16 v[112:127], v[60:63], v[228:231], v[112:127]
    ds_read_b64_tr_b16 v[52:53], v41 offset:57600
    ds_read_b64_tr_b16 v[54:55], v41 offset:58112
    s_waitcnt vmcnt(9) lgkmcnt(8)
    v_mfma_f32_32x32x16_bf16 v[96:111], v[64:67], v[232:235], v[96:111]
    ds_read_b64_tr_b16 v[56:57], v41 offset:59392
    ds_read_b64_tr_b16 v[58:59], v41 offset:59904
    v_mul_f32 v129, 0x3b000000, v129
    v_fma_f32 v129, -v128, v128, v129
    v_mfma_f32_32x32x16_bf16 v[112:127], v[68:71], v[232:235], v[112:127]
    ds_read_b64_tr_b16 v[60:61], v41 offset:59648
    ds_read_b64_tr_b16 v[62:63], v41 offset:60160
    s_waitcnt vmcnt(8) lgkmcnt(8)
    v_mfma_f32_32x32x16_bf16 v[96:111], v[72:75], v[236:239], v[96:111]
    ds_read_b64_tr_b16 v[64:65], v41 offset:61440
    ds_read_b64_tr_b16 v[66:67], v41 offset:61952
    v_max_f32 v129, 0, v129
    v_add_f32 v129, 0x3727c5ac, v129
    v_mfma_f32_32x32x16_bf16 v[112:127], v[76:79], v[236:239], v[112:127]
    ds_read_b64_tr_b16 v[68:69], v41 offset:61696
    ds_read_b64_tr_b16 v[70:71], v41 offset:62208
    s_waitcnt vmcnt(7) lgkmcnt(8)
    v_mfma_f32_32x32x16_bf16 v[96:111], v[48:51], v[240:243], v[96:111]
    ds_read_b64_tr_b16 v[72:73], v41 offset:63488
    ds_read_b64_tr_b16 v[74:75], v41 offset:64000
    v_rsq_f32 v130, v129
    v_sub_f32 v12, 0, v128
    v_mfma_f32_32x32x16_bf16 v[112:127], v[52:55], v[240:243], v[112:127]
    ds_read_b64_tr_b16 v[76:77], v41 offset:63744
    ds_read_b64_tr_b16 v[78:79], v41 offset:64256
    s_waitcnt vmcnt(6) lgkmcnt(8)
    v_mfma_f32_32x32x16_bf16 v[96:111], v[56:59], v[244:247], v[96:111]
    v_mul_f32 v18, v129, v130
    v_mul_f32 v16, 0xc0135761, v130
    ds_read_b64_tr_b16 v[48:49], v40 offset:8192
    ds_read_b64_tr_b16 v[50:51], v40 offset:8448
    v_mfma_f32_32x32x16_bf16 v[112:127], v[60:63], v[244:247], v[112:127]
    ds_read_b64_tr_b16 v[52:53], v40 offset:9216
    ds_read_b64_tr_b16 v[54:55], v40 offset:9472
    s_waitcnt vmcnt(5) lgkmcnt(8)
    v_mfma_f32_32x32x16_bf16 v[96:111], v[64:67], v[248:251], v[96:111]
    v_mul_f32 v131, v130, v130
    v_mul_f32 v131, v131, v130
    ds_read_b64_tr_b16 v[56:57], v40 offset:10240
    ds_read_b64_tr_b16 v[58:59], v40 offset:10496
    v_mfma_f32_32x32x16_bf16 v[112:127], v[68:71], v[248:251], v[112:127]
    s_waitcnt vmcnt(4) lgkmcnt(6)
    v_mfma_f32_32x32x16_bf16 v[96:111], v[72:75], v[252:255], v[96:111]
    v_mul_f32 v14, 0xbdd2d3e8, v131
    v_mfma_f32_32x32x16_bf16 v[112:127], v[76:79], v[252:255], v[112:127]
    s_barrier
    ds_read_b128 v[64:67], v42 offset:0
    ds_read_b128 v[68:71], v42 offset:16
    ds_read_b128 v[72:75], v42 offset:32
    ds_read_b128 v[76:79], v42 offset:48
    s_waitcnt lgkmcnt(8)
    v_mfma_f32_32x32x16_bf16 v[80:95], v[48:51], v[160:163], v[80:95]
    ds_read_b64_tr_b16 v[60:61], v40 offset:11264
    ds_read_b64_tr_b16 v[62:63], v40 offset:11520
    s_waitcnt lgkmcnt(8)
    v_mfma_f32_32x32x16_bf16 v[80:95], v[52:55], v[164:167], v[80:95]
    ds_read_b64_tr_b16 v[48:49], v40 offset:12288
    ds_read_b64_tr_b16 v[50:51], v40 offset:12544
    s_waitcnt lgkmcnt(4)
    v_pk_fma_f32 v[96:97], v[64:65], v[12:13], v[96:97] op_sel_hi:[1,0,1]
    v_pk_fma_f32 v[98:99], v[66:67], v[12:13], v[98:99] op_sel_hi:[1,0,1]
    v_pk_mul_f32 v[28:29], v[96:97], v[96:97]
    v_pk_mul_f32 v[30:31], v[98:99], v[98:99]
    v_pk_fma_f32 v[28:29], v[28:29], v[14:15], v[16:17] op_sel_hi:[1,0,0]
    v_pk_fma_f32 v[30:31], v[30:31], v[14:15], v[16:17] op_sel_hi:[1,0,0]
    v_pk_mul_f32 v[28:29], v[28:29], v[96:97]
    s_waitcnt lgkmcnt(8)
    v_mfma_f32_32x32x16_bf16 v[80:95], v[56:59], v[168:171], v[80:95]
    ds_read_b64_tr_b16 v[52:53], v40 offset:13312
    ds_read_b64_tr_b16 v[54:55], v40 offset:13568
    v_pk_mul_f32 v[30:31], v[30:31], v[98:99]
    v_exp_f32 v28, v28
    v_exp_f32 v30, v30
    v_exp_f32 v29, v29
    v_exp_f32 v31, v31
    v_pk_fma_f32 v[28:29], v[28:29], v[18:19], v[18:19] op_sel_hi:[1,0,0]
    v_pk_fma_f32 v[30:31], v[30:31], v[18:19], v[18:19] op_sel_hi:[1,0,0]
    v_rcp_f32 v28, v28
    s_waitcnt lgkmcnt(4)
    v_mfma_f32_32x32x16_bf16 v[80:95], v[60:63], v[172:175], v[80:95]
    ds_read_b64_tr_b16 v[56:57], v40 offset:14336
    ds_read_b64_tr_b16 v[58:59], v40 offset:14592
    v_rcp_f32 v30, v30
    v_rcp_f32 v29, v29
    v_rcp_f32 v31, v31
    v_pk_mul_f32 v[28:29], v[28:29], v[96:97]
    v_pk_mul_f32 v[30:31], v[30:31], v[98:99]
    v_cvt_pk_bf16_f32 v32, v28, v29
    v_cvt_pk_bf16_f32 v33, v30, v31
    v_pk_fma_f32 v[100:101], v[68:69], v[12:13], v[100:101] op_sel_hi:[1,0,1]
    s_waitcnt lgkmcnt(4)
    v_mfma_f32_32x32x16_bf16 v[80:95], v[48:51], v[176:179], v[80:95]
    ds_read_b64_tr_b16 v[60:61], v40 offset:15360
    ds_read_b64_tr_b16 v[62:63], v40 offset:15616
    v_pk_fma_f32 v[102:103], v[70:71], v[12:13], v[102:103] op_sel_hi:[1,0,1]
    v_pk_mul_f32 v[28:29], v[100:101], v[100:101]
    v_pk_mul_f32 v[30:31], v[102:103], v[102:103]
    v_pk_fma_f32 v[28:29], v[28:29], v[14:15], v[16:17] op_sel_hi:[1,0,0]
    v_pk_fma_f32 v[30:31], v[30:31], v[14:15], v[16:17] op_sel_hi:[1,0,0]
    v_pk_mul_f32 v[28:29], v[28:29], v[100:101]
    v_pk_mul_f32 v[30:31], v[30:31], v[102:103]
    v_exp_f32 v28, v28
    s_waitcnt lgkmcnt(4)
    v_mfma_f32_32x32x16_bf16 v[80:95], v[52:55], v[180:183], v[80:95]
    ds_read_b64_tr_b16 v[48:49], v40 offset:16384
    ds_read_b64_tr_b16 v[50:51], v40 offset:16640
    v_exp_f32 v30, v30
    v_exp_f32 v29, v29
    v_exp_f32 v31, v31
    v_pk_fma_f32 v[28:29], v[28:29], v[18:19], v[18:19] op_sel_hi:[1,0,0]
    v_pk_fma_f32 v[30:31], v[30:31], v[18:19], v[18:19] op_sel_hi:[1,0,0]
    v_rcp_f32 v28, v28
    v_rcp_f32 v30, v30
    v_rcp_f32 v29, v29
    s_waitcnt lgkmcnt(4)
    v_mfma_f32_32x32x16_bf16 v[80:95], v[56:59], v[184:187], v[80:95]
    ds_read_b64_tr_b16 v[52:53], v40 offset:17408
    ds_read_b64_tr_b16 v[54:55], v40 offset:17664
    v_rcp_f32 v31, v31
    v_pk_mul_f32 v[28:29], v[28:29], v[100:101]
    v_pk_mul_f32 v[30:31], v[30:31], v[102:103]
    v_cvt_pk_bf16_f32 v34, v28, v29
    v_cvt_pk_bf16_f32 v35, v30, v31
    buffer_store_dwordx4 v[32:35], v19, s[28:31], s67 offen offset:0 sc1
    v_pk_fma_f32 v[104:105], v[72:73], v[12:13], v[104:105] op_sel_hi:[1,0,1]
    v_pk_fma_f32 v[106:107], v[74:75], v[12:13], v[106:107] op_sel_hi:[1,0,1]
    s_waitcnt lgkmcnt(4)
    v_mfma_f32_32x32x16_bf16 v[80:95], v[60:63], v[188:191], v[80:95]
    ds_read_b64_tr_b16 v[56:57], v40 offset:18432
    ds_read_b64_tr_b16 v[58:59], v40 offset:18688
    v_pk_mul_f32 v[28:29], v[104:105], v[104:105]
    v_pk_mul_f32 v[30:31], v[106:107], v[106:107]
    v_pk_fma_f32 v[28:29], v[28:29], v[14:15], v[16:17] op_sel_hi:[1,0,0]
    v_pk_fma_f32 v[30:31], v[30:31], v[14:15], v[16:17] op_sel_hi:[1,0,0]
    v_pk_mul_f32 v[28:29], v[28:29], v[104:105]
    v_pk_mul_f32 v[30:31], v[30:31], v[106:107]
    v_exp_f32 v28, v28
    v_exp_f32 v30, v30
    s_waitcnt lgkmcnt(4)
    v_mfma_f32_32x32x16_bf16 v[80:95], v[48:51], v[192:195], v[80:95]
    ds_read_b64_tr_b16 v[60:61], v40 offset:19456
    ds_read_b64_tr_b16 v[62:63], v40 offset:19712
    v_exp_f32 v29, v29
    v_exp_f32 v31, v31
    v_pk_fma_f32 v[28:29], v[28:29], v[18:19], v[18:19] op_sel_hi:[1,0,0]
    v_pk_fma_f32 v[30:31], v[30:31], v[18:19], v[18:19] op_sel_hi:[1,0,0]
    v_rcp_f32 v28, v28
    v_rcp_f32 v30, v30
    v_rcp_f32 v29, v29
    v_rcp_f32 v31, v31
    s_waitcnt lgkmcnt(4)
    v_mfma_f32_32x32x16_bf16 v[80:95], v[52:55], v[196:199], v[80:95]
    ds_read_b64_tr_b16 v[48:49], v40 offset:20480
    ds_read_b64_tr_b16 v[50:51], v40 offset:20736
    v_pk_mul_f32 v[28:29], v[28:29], v[104:105]
    v_pk_mul_f32 v[30:31], v[30:31], v[106:107]
    v_cvt_pk_bf16_f32 v36, v28, v29
    v_cvt_pk_bf16_f32 v37, v30, v31
    v_pk_fma_f32 v[108:109], v[76:77], v[12:13], v[108:109] op_sel_hi:[1,0,1]
    v_pk_fma_f32 v[110:111], v[78:79], v[12:13], v[110:111] op_sel_hi:[1,0,1]
    v_pk_mul_f32 v[28:29], v[108:109], v[108:109]
    v_pk_mul_f32 v[30:31], v[110:111], v[110:111]
    s_waitcnt lgkmcnt(4)
    v_mfma_f32_32x32x16_bf16 v[80:95], v[56:59], v[200:203], v[80:95]
    ds_read_b64_tr_b16 v[52:53], v40 offset:21504
    ds_read_b64_tr_b16 v[54:55], v40 offset:21760
    v_pk_fma_f32 v[28:29], v[28:29], v[14:15], v[16:17] op_sel_hi:[1,0,0]
    v_pk_fma_f32 v[30:31], v[30:31], v[14:15], v[16:17] op_sel_hi:[1,0,0]
    v_pk_mul_f32 v[28:29], v[28:29], v[108:109]
    v_pk_mul_f32 v[30:31], v[30:31], v[110:111]
    v_exp_f32 v28, v28
    v_exp_f32 v30, v30
    v_exp_f32 v29, v29
    v_exp_f32 v31, v31
    s_waitcnt lgkmcnt(4)
    v_mfma_f32_32x32x16_bf16 v[80:95], v[60:63], v[204:207], v[80:95]
    ds_read_b64_tr_b16 v[56:57], v40 offset:22528
    ds_read_b64_tr_b16 v[58:59], v40 offset:22784
    v_pk_fma_f32 v[28:29], v[28:29], v[18:19], v[18:19] op_sel_hi:[1,0,0]
    v_pk_fma_f32 v[30:31], v[30:31], v[18:19], v[18:19] op_sel_hi:[1,0,0]
    v_rcp_f32 v28, v28
    v_rcp_f32 v30, v30
    v_rcp_f32 v29, v29
    v_rcp_f32 v31, v31
    v_pk_mul_f32 v[28:29], v[28:29], v[108:109]
    v_pk_mul_f32 v[30:31], v[30:31], v[110:111]
    s_waitcnt lgkmcnt(4)
    v_mfma_f32_32x32x16_bf16 v[80:95], v[48:51], v[208:211], v[80:95]
    ds_read_b64_tr_b16 v[60:61], v40 offset:23552
    ds_read_b64_tr_b16 v[62:63], v40 offset:23808
    v_cvt_pk_bf16_f32 v38, v28, v29
    v_cvt_pk_bf16_f32 v39, v30, v31
    buffer_store_dwordx4 v[36:39], v19, s[28:31], s67 offen offset:1024 sc1
    s_add_u32 s53, s67, 4096
    ds_read_b128 v[64:67], v42 offset:128
    ds_read_b128 v[68:71], v42 offset:144
    ds_read_b128 v[72:75], v42 offset:160
    ds_read_b128 v[76:79], v42 offset:176
    s_waitcnt lgkmcnt(0)
    v_pk_fma_f32 v[112:113], v[64:65], v[12:13], v[112:113] op_sel_hi:[1,0,1]
    v_pk_fma_f32 v[114:115], v[66:67], v[12:13], v[114:115] op_sel_hi:[1,0,1]
    s_waitcnt lgkmcnt(8)
    v_mfma_f32_32x32x16_bf16 v[80:95], v[52:55], v[212:215], v[80:95]
    ds_read_b64_tr_b16 v[48:49], v40 offset:24576
    ds_read_b64_tr_b16 v[50:51], v40 offset:24832
    v_pk_mul_f32 v[28:29], v[112:113], v[112:113]
    v_pk_mul_f32 v[30:31], v[114:115], v[114:115]
    v_pk_fma_f32 v[28:29], v[28:29], v[14:15], v[16:17] op_sel_hi:[1,0,0]
    v_pk_fma_f32 v[30:31], v[30:31], v[14:15], v[16:17] op_sel_hi:[1,0,0]
    v_pk_mul_f32 v[28:29], v[28:29], v[112:113]
    v_pk_mul_f32 v[30:31], v[30:31], v[114:115]
    v_exp_f32 v28, v28
    v_exp_f32 v30, v30
    s_waitcnt lgkmcnt(8)
    v_mfma_f32_32x32x16_bf16 v[80:95], v[56:59], v[216:219], v[80:95]
    ds_read_b64_tr_b16 v[52:53], v40 offset:25600
    ds_read_b64_tr_b16 v[54:55], v40 offset:25856
    v_exp_f32 v29, v29
    v_exp_f32 v31, v31
    v_pk_fma_f32 v[28:29], v[28:29], v[18:19], v[18:19] op_sel_hi:[1,0,0]
    v_pk_fma_f32 v[30:31], v[30:31], v[18:19], v[18:19] op_sel_hi:[1,0,0]
    v_rcp_f32 v28, v28
    v_rcp_f32 v30, v30
    v_rcp_f32 v29, v29
    v_rcp_f32 v31, v31
    s_waitcnt lgkmcnt(8)
    v_mfma_f32_32x32x16_bf16 v[80:95], v[60:63], v[220:223], v[80:95]
    ds_read_b64_tr_b16 v[56:57], v40 offset:26624
    ds_read_b64_tr_b16 v[58:59], v40 offset:26880
    v_pk_mul_f32 v[28:29], v[28:29], v[112:113]
    v_pk_mul_f32 v[30:31], v[30:31], v[114:115]
    v_cvt_pk_bf16_f32 v32, v28, v29
    v_cvt_pk_bf16_f32 v33, v30, v31
    v_pk_fma_f32 v[116:117], v[68:69], v[12:13], v[116:117] op_sel_hi:[1,0,1]
    v_pk_fma_f32 v[118:119], v[70:71], v[12:13], v[118:119] op_sel_hi:[1,0,1]
    v_pk_mul_f32 v[28:29], v[116:117], v[116:117]
    v_pk_mul_f32 v[30:31], v[118:119], v[118:119]
    s_waitcnt lgkmcnt(4)
    v_mfma_f32_32x32x16_bf16 v[80:95], v[48:51], v[224:227], v[80:95]
    ds_read_b64_tr_b16 v[60:61], v40 offset:27648
    ds_read_b64_tr_b16 v[62:63], v40 offset:27904
    v_pk_fma_f32 v[28:29], v[28:29], v[14:15], v[16:17] op_sel_hi:[1,0,0]
    v_pk_fma_f32 v[30:31], v[30:31], v[14:15], v[16:17] op_sel_hi:[1,0,0]
    v_pk_mul_f32 v[28:29], v[28:29], v[116:117]
    v_pk_mul_f32 v[30:31], v[30:31], v[118:119]
    v_exp_f32 v28, v28
    v_exp_f32 v30, v30
    v_exp_f32 v29, v29
    v_exp_f32 v31, v31
    s_waitcnt lgkmcnt(4)
    v_mfma_f32_32x32x16_bf16 v[80:95], v[52:55], v[228:231], v[80:95]
    ds_read_b64_tr_b16 v[48:49], v40 offset:28672
    ds_read_b64_tr_b16 v[50:51], v40 offset:28928
    v_pk_fma_f32 v[28:29], v[28:29], v[18:19], v[18:19] op_sel_hi:[1,0,0]
    v_pk_fma_f32 v[30:31], v[30:31], v[18:19], v[18:19] op_sel_hi:[1,0,0]
    v_rcp_f32 v28, v28
    v_rcp_f32 v30, v30
    v_rcp_f32 v29, v29
    v_rcp_f32 v31, v31
    v_pk_mul_f32 v[28:29], v[28:29], v[116:117]
    v_pk_mul_f32 v[30:31], v[30:31], v[118:119]
    s_waitcnt lgkmcnt(4)
    v_mfma_f32_32x32x16_bf16 v[80:95], v[56:59], v[232:235], v[80:95]
    ds_read_b64_tr_b16 v[52:53], v40 offset:29696
    ds_read_b64_tr_b16 v[54:55], v40 offset:29952
    v_cvt_pk_bf16_f32 v34, v28, v29
    v_cvt_pk_bf16_f32 v35, v30, v31
    buffer_store_dwordx4 v[32:35], v19, s[28:31], s53 offen offset:0 sc1
    v_pk_fma_f32 v[120:121], v[72:73], v[12:13], v[120:121] op_sel_hi:[1,0,1]
    v_pk_fma_f32 v[122:123], v[74:75], v[12:13], v[122:123] op_sel_hi:[1,0,1]
    v_pk_mul_f32 v[28:29], v[120:121], v[120:121]
    v_pk_mul_f32 v[30:31], v[122:123], v[122:123]
    v_pk_fma_f32 v[28:29], v[28:29], v[14:15], v[16:17] op_sel_hi:[1,0,0]
    s_waitcnt lgkmcnt(4)
    v_mfma_f32_32x32x16_bf16 v[80:95], v[60:63], v[236:239], v[80:95]
    ds_read_b64_tr_b16 v[56:57], v40 offset:30720
    ds_read_b64_tr_b16 v[58:59], v40 offset:30976
    v_pk_fma_f32 v[30:31], v[30:31], v[14:15], v[16:17] op_sel_hi:[1,0,0]
    v_pk_mul_f32 v[28:29], v[28:29], v[120:121]
    v_pk_mul_f32 v[30:31], v[30:31], v[122:123]
    v_exp_f32 v28, v28
    v_exp_f32 v30, v30
    v_exp_f32 v29, v29
    v_exp_f32 v31, v31
    v_pk_fma_f32 v[28:29], v[28:29], v[18:19], v[18:19] op_sel_hi:[1,0,0]
    s_waitcnt lgkmcnt(4)
    v_mfma_f32_32x32x16_bf16 v[80:95], v[48:51], v[240:243], v[80:95]
    ds_read_b64_tr_b16 v[60:61], v40 offset:31744
    ds_read_b64_tr_b16 v[62:63], v40 offset:32000
    v_pk_fma_f32 v[30:31], v[30:31], v[18:19], v[18:19] op_sel_hi:[1,0,0]
    v_rcp_f32 v28, v28
    v_rcp_f32 v30, v30
    v_rcp_f32 v29, v29
    v_rcp_f32 v31, v31
    v_pk_mul_f32 v[28:29], v[28:29], v[120:121]
    v_pk_mul_f32 v[30:31], v[30:31], v[122:123]
    v_cvt_pk_bf16_f32 v36, v28, v29
    s_waitcnt lgkmcnt(4)
    v_mfma_f32_32x32x16_bf16 v[80:95], v[52:55], v[244:247], v[80:95]
    v_cvt_pk_bf16_f32 v37, v30, v31
    v_pk_fma_f32 v[124:125], v[76:77], v[12:13], v[124:125] op_sel_hi:[1,0,1]
    v_pk_fma_f32 v[126:127], v[78:79], v[12:13], v[126:127] op_sel_hi:[1,0,1]
    v_pk_mul_f32 v[28:29], v[124:125], v[124:125]
    v_pk_mul_f32 v[30:31], v[126:127], v[126:127]
    v_pk_fma_f32 v[28:29], v[28:29], v[14:15], v[16:17] op_sel_hi:[1,0,0]
    v_pk_fma_f32 v[30:31], v[30:31], v[14:15], v[16:17] op_sel_hi:[1,0,0]
    v_pk_mul_f32 v[28:29], v[28:29], v[124:125]
    s_waitcnt lgkmcnt(2)
    v_mfma_f32_32x32x16_bf16 v[80:95], v[56:59], v[248:251], v[80:95]
    v_pk_mul_f32 v[30:31], v[30:31], v[126:127]
    v_exp_f32 v28, v28
    v_exp_f32 v30, v30
    v_exp_f32 v29, v29
    v_exp_f32 v31, v31
    v_pk_fma_f32 v[28:29], v[28:29], v[18:19], v[18:19] op_sel_hi:[1,0,0]
    v_pk_fma_f32 v[30:31], v[30:31], v[18:19], v[18:19] op_sel_hi:[1,0,0]
    v_rcp_f32 v28, v28
    s_waitcnt lgkmcnt(0)
    v_mfma_f32_32x32x16_bf16 v[80:95], v[60:63], v[252:255], v[80:95]
    v_rcp_f32 v30, v30
    v_rcp_f32 v29, v29
    v_rcp_f32 v31, v31
    v_pk_mul_f32 v[28:29], v[28:29], v[124:125]
    v_pk_mul_f32 v[30:31], v[30:31], v[126:127]
    v_cvt_pk_bf16_f32 v38, v28, v29
    v_cvt_pk_bf16_f32 v39, v30, v31
    buffer_store_dwordx4 v[36:39], v19, s[28:31], s53 offen offset:1024 sc1
    s_barrier
    ds_read_b128 v[64:67], v42 offset:256
    ds_read_b128 v[68:71], v42 offset:272
    ds_read_b128 v[72:75], v42 offset:288
    ds_read_b128 v[76:79], v42 offset:304
    s_lshl_b32 s50, s42, 16
    s_lshl_b32 s51, s43, 13
    s_add_u32 s50, s50, s51
    s_lshl_b32 s51, s48, 12
    s_add_u32 s50, s50, s51
    s_add_u32 s50, s50, 3145728
    buffer_load_dwordx4 v[128:131], v19, s[28:31], s50 offen sc1
    buffer_load_dwordx4 v[132:135], v19, s[28:31], s50 offen offset:1024 sc1
    s_lshl_b32 s63, s45, 7
    s_add_u32 s63, s63, 12288
    s_lshl_b32 s65, s46, 2
    s_add_u32 s65, s65, s63
    s_waitcnt lgkmcnt(0)
    v_pk_fma_f32 v[80:81], v[64:65], v[12:13], v[80:81] op_sel_hi:[1,0,1]
    v_pk_fma_f32 v[82:83], v[66:67], v[12:13], v[82:83] op_sel_hi:[1,0,1]
    v_pk_mul_f32 v[28:29], v[80:81], v[80:81]
    v_pk_mul_f32 v[30:31], v[82:83], v[82:83]
    v_pk_fma_f32 v[28:29], v[28:29], v[14:15], v[16:17] op_sel_hi:[1,0,0]
    v_pk_fma_f32 v[30:31], v[30:31], v[14:15], v[16:17] op_sel_hi:[1,0,0]
    v_pk_mul_f32 v[28:29], v[28:29], v[80:81]
    v_pk_mul_f32 v[30:31], v[30:31], v[82:83]
    v_exp_f32 v28, v28
    v_exp_f32 v30, v30
    v_exp_f32 v29, v29
    v_exp_f32 v31, v31
    v_pk_fma_f32 v[28:29], v[28:29], v[18:19], v[18:19] op_sel_hi:[1,0,0]
    v_pk_fma_f32 v[30:31], v[30:31], v[18:19], v[18:19] op_sel_hi:[1,0,0]
    v_rcp_f32 v28, v28
    v_rcp_f32 v30, v30
    v_rcp_f32 v29, v29
    v_rcp_f32 v31, v31
    v_pk_mul_f32 v[28:29], v[28:29], v[80:81]
    v_pk_mul_f32 v[30:31], v[30:31], v[82:83]
    v_cvt_pk_bf16_f32 v32, v28, v29
    v_cvt_pk_bf16_f32 v33, v30, v31
    v_pk_fma_f32 v[84:85], v[68:69], v[12:13], v[84:85] op_sel_hi:[1,0,1]
    v_pk_fma_f32 v[86:87], v[70:71], v[12:13], v[86:87] op_sel_hi:[1,0,1]
    v_pk_mul_f32 v[28:29], v[84:85], v[84:85]
    v_pk_mul_f32 v[30:31], v[86:87], v[86:87]
    v_pk_fma_f32 v[28:29], v[28:29], v[14:15], v[16:17] op_sel_hi:[1,0,0]
    v_pk_fma_f32 v[30:31], v[30:31], v[14:15], v[16:17] op_sel_hi:[1,0,0]
    v_pk_mul_f32 v[28:29], v[28:29], v[84:85]
    v_pk_mul_f32 v[30:31], v[30:31], v[86:87]
    v_exp_f32 v28, v28
    v_exp_f32 v30, v30
    v_exp_f32 v29, v29
    v_exp_f32 v31, v31
    v_pk_fma_f32 v[28:29], v[28:29], v[18:19], v[18:19] op_sel_hi:[1,0,0]
    v_pk_fma_f32 v[30:31], v[30:31], v[18:19], v[18:19] op_sel_hi:[1,0,0]
    v_rcp_f32 v28, v28
    v_rcp_f32 v30, v30
    v_rcp_f32 v29, v29
    v_rcp_f32 v31, v31
    v_pk_mul_f32 v[28:29], v[28:29], v[84:85]
    v_pk_mul_f32 v[30:31], v[30:31], v[86:87]
    v_cvt_pk_bf16_f32 v34, v28, v29
    v_cvt_pk_bf16_f32 v35, v30, v31
    buffer_store_dwordx4 v[32:35], v17, s[28:31], s68 offen offset:0 sc1
    v_pk_fma_f32 v[88:89], v[72:73], v[12:13], v[88:89] op_sel_hi:[1,0,1]
    v_pk_fma_f32 v[90:91], v[74:75], v[12:13], v[90:91] op_sel_hi:[1,0,1]
    v_pk_mul_f32 v[28:29], v[88:89], v[88:89]
    v_pk_mul_f32 v[30:31], v[90:91], v[90:91]
    v_pk_fma_f32 v[28:29], v[28:29], v[14:15], v[16:17] op_sel_hi:[1,0,0]
    v_pk_fma_f32 v[30:31], v[30:31], v[14:15], v[16:17] op_sel_hi:[1,0,0]
    v_pk_mul_f32 v[28:29], v[28:29], v[88:89]
    v_pk_mul_f32 v[30:31], v[30:31], v[90:91]
    v_exp_f32 v28, v28
    v_exp_f32 v30, v30
    v_exp_f32 v29, v29
    v_exp_f32 v31, v31
    v_pk_fma_f32 v[28:29], v[28:29], v[18:19], v[18:19] op_sel_hi:[1,0,0]
    v_pk_fma_f32 v[30:31], v[30:31], v[18:19], v[18:19] op_sel_hi:[1,0,0]
    v_rcp_f32 v28, v28
    v_rcp_f32 v30, v30
    v_rcp_f32 v29, v29
    v_rcp_f32 v31, v31
    v_pk_mul_f32 v[28:29], v[28:29], v[88:89]
    v_pk_mul_f32 v[30:31], v[30:31], v[90:91]
    v_cvt_pk_bf16_f32 v36, v28, v29
    v_cvt_pk_bf16_f32 v37, v30, v31
    v_pk_fma_f32 v[92:93], v[76:77], v[12:13], v[92:93] op_sel_hi:[1,0,1]
    v_pk_fma_f32 v[94:95], v[78:79], v[12:13], v[94:95] op_sel_hi:[1,0,1]
    v_pk_mul_f32 v[28:29], v[92:93], v[92:93]
    v_pk_mul_f32 v[30:31], v[94:95], v[94:95]
    v_pk_fma_f32 v[28:29], v[28:29], v[14:15], v[16:17] op_sel_hi:[1,0,0]
    v_pk_fma_f32 v[30:31], v[30:31], v[14:15], v[16:17] op_sel_hi:[1,0,0]
    v_pk_mul_f32 v[28:29], v[28:29], v[92:93]
    v_pk_mul_f32 v[30:31], v[30:31], v[94:95]
    v_exp_f32 v28, v28
    v_exp_f32 v30, v30
    v_exp_f32 v29, v29
    v_exp_f32 v31, v31
    v_pk_fma_f32 v[28:29], v[28:29], v[18:19], v[18:19] op_sel_hi:[1,0,0]
    v_pk_fma_f32 v[30:31], v[30:31], v[18:19], v[18:19] op_sel_hi:[1,0,0]
    v_rcp_f32 v28, v28
    v_rcp_f32 v30, v30
    v_rcp_f32 v29, v29
    v_rcp_f32 v31, v31
    v_pk_mul_f32 v[28:29], v[28:29], v[92:93]
    v_pk_mul_f32 v[30:31], v[30:31], v[94:95]
    v_cvt_pk_bf16_f32 v38, v28, v29
    v_cvt_pk_bf16_f32 v39, v30, v31
    buffer_store_dwordx4 v[36:39], v17, s[28:31], s68 offen offset:1024 sc1
    s_lshl_b32 s50, s48, 14
    v_add_u32 v40, s50, v11
    ds_read_b64_tr_b16 v[208:209], v40 offset:32768
    ds_read_b64_tr_b16 v[210:211], v40 offset:33280
    s_waitcnt vmcnt(2)
    ds_read_b64_tr_b16 v[212:213], v40 offset:33024
    v_lshlrev_b32 v96, 16, v128
    v_and_b32 v97, 0xffff0000, v128
    ds_read_b64_tr_b16 v[214:215], v40 offset:33536
    ds_read_b64_tr_b16 v[216:217], v40 offset:34816
    v_lshlrev_b32 v98, 16, v129
    v_and_b32 v99, 0xffff0000, v129
    ds_read_b64_tr_b16 v[218:219], v40 offset:35328
    v_lshlrev_b32 v100, 16, v130
    v_and_b32 v101, 0xffff0000, v130
    ds_read_b64_tr_b16 v[220:221], v40 offset:35072
    ds_read_b64_tr_b16 v[222:223], v40 offset:35584
    v_lshlrev_b32 v102, 16, v131
    v_and_b32 v103, 0xffff0000, v131
    ds_read_b64_tr_b16 v[224:225], v40 offset:36864
    v_lshlrev_b32 v104, 16, v132
    v_and_b32 v105, 0xffff0000, v132
    ds_read_b64_tr_b16 v[226:227], v40 offset:37376
    ds_read_b64_tr_b16 v[228:229], v40 offset:37120
    v_lshlrev_b32 v106, 16, v133
    v_and_b32 v107, 0xffff0000, v133
    ds_read_b64_tr_b16 v[230:231], v40 offset:37632
    v_lshlrev_b32 v108, 16, v134
    v_and_b32 v109, 0xffff0000, v134
    ds_read_b64_tr_b16 v[232:233], v40 offset:38912
    ds_read_b64_tr_b16 v[234:235], v40 offset:39424
    v_lshlrev_b32 v110, 16, v135
    v_and_b32 v111, 0xffff0000, v135
    ds_read_b64_tr_b16 v[236:237], v40 offset:39168
    s_mul_i32 s59, s42, 176128
    s_waitcnt lgkmcnt(14)
    ds_read_b64_tr_b16 v[238:239], v40 offset:39680
    s_waitcnt lgkmcnt(14)
    ds_read_b64_tr_b16 v[240:241], v40 offset:40960
    s_add_u32 s59, s59, 5242880
    s_waitcnt lgkmcnt(14)
    ds_read_b64_tr_b16 v[242:243], v40 offset:41472
    s_lshl_b32 s50, s48, 16
    s_waitcnt lgkmcnt(14)
    ds_read_b64_tr_b16 v[244:245], v40 offset:41216
    s_waitcnt lgkmcnt(14)
    ds_read_b64_tr_b16 v[246:247], v40 offset:41728
    s_add_u32 s66, s59, s50
    s_waitcnt lgkmcnt(14)
    ds_read_b64_tr_b16 v[248:249], v40 offset:43008
    s_mul_i32 s50, s48, 22528
    s_waitcnt lgkmcnt(14)
    ds_read_b64_tr_b16 v[250:251], v40 offset:43520
    s_waitcnt lgkmcnt(14)
    ds_read_b64_tr_b16 v[252:253], v40 offset:43264
    s_add_u32 s59, s59, s50
    s_waitcnt lgkmcnt(14)
    ds_read_b64_tr_b16 v[254:255], v40 offset:43776
    s_add_u32 s59, s59, 131072
    s_mul_i32 s50, s48, 10240
    s_add_u32 s50, s50, 131072
    v_add_u32 v41, s50, v11
    s_lshl_b32 s50, s48, 15
    s_add_u32 s50, s50, 65536
    v_add_u32 v42, s50, v11
    s_lshl_b32 s50, s41, 12
    s_add_u32 s50, s50, 131072
    v_add_u32 v43, s50, v7
    v_xor_b32 v128, 8192, v43
    v_and_b32 v1, 1, v9
    v_and_b32 v3, 3, v0
    v_lshrrev_b32 v4, 5, v0
    v_lshlrev_b32 v5, 11, v4
    v_add_u32 v5, v5, v10
    v_lshl_add_u32 v5, v1, 5, v5
    v_lshl_add_u32 v5, v3, 3, v5
    s_lshl_b32 s50, s48, 12
    s_lshl_b32 s51, s47, 8
    s_add_u32 s50, s50, s51
    s_add_u32 s50, s50, 151552
    v_add_u32 v129, s50, v5
    v_and_b32 v5, 31, v0
    v_lshlrev_b32 v5, 10, v5
    v_lshl_add_u32 v130, v4, 5, v5
    s_lshl_b32 s58, s42, 1
    s_add_u32 s58, s58, s47
    s_lshl_b32 s58, s58, 15
    s_lshl_b32 s51, s48, 6
    s_add_u32 s58, s58, s51
    s_add_u32 s58, s58, s49
    v_mov_b32 v12, 0xbfb8aa3b
    s_waitcnt vmcnt(0) lgkmcnt(0)
    s_barrier
    s_cmp_lg_u32 s41, 0
    s_cbranch_scc1 L_ho_18
    s_mov_b64 exec, 1
    s_cmp_eq_u32 s64, 0
    s_cbranch_scc1 L_hof_19
    buffer_store_dword v13, v15, s[28:31], s65 offen
    s_branch L_hop_20_a
L_hof_19:
    buffer_store_dword v13, v15, s[28:31], s65 offen sc1
L_hop_20_a:
    s_mov_b32 s62, 60000
    s_mov_b64 exec, 0xffff
L_hop_20:
    buffer_load_dword v2, v15, s[28:31], s63 offen sc1
    s_waitcnt vmcnt(0)
    v_cmp_ne_u32 vcc, s57, v2
    s_cbranch_vccz L_hod_21
    s_sub_u32 s62, s62, 1
    s_cbranch_scc0 L_hop_20
L_hod_21:
    s_mov_b64 exec, -1
L_ho_18:
    s_barrier
    buffer_load_dwordx4 v[140:143], v44, s[28:31], s66 offen offset:0 sc1
    buffer_load_dwordx4 v[144:147], v44, s[28:31], s66 offen offset:2048 sc1
    buffer_load_dwordx4 v[148:151], v45, s[28:31], s66 offen offset:0 sc1
    buffer_load_dwordx4 v[152:155], v45, s[28:31], s66 offen offset:2048 sc1
    buffer_load_dwordx4 v[156:159], v46, s[28:31], s66 offen offset:0 sc1
    buffer_load_dwordx4 v[160:163], v46, s[28:31], s66 offen offset:2048 sc1
    buffer_load_dwordx4 v[164:167], v47, s[28:31], s66 offen offset:0 sc1
    buffer_load_dwordx4 v[168:171], v47, s[28:31], s66 offen offset:2048 sc1
    s_add_u32 s66, s66, 16384
    buffer_load_dwordx4 v[172:175], v44, s[28:31], s66 offen offset:0 sc1
    buffer_load_dwordx4 v[176:179], v44, s[28:31], s66 offen offset:2048 sc1
    buffer_load_dwordx4 v[180:183], v45, s[28:31], s66 offen offset:0 sc1
    buffer_load_dwordx4 v[184:187], v45, s[28:31], s66 offen offset:2048 sc1
    buffer_load_dwordx4 v[188:191], v46, s[28:31], s66 offen offset:0 sc1
    buffer_load_dwordx4 v[192:195], v46, s[28:31], s66 offen offset:2048 sc1
    buffer_load_dwordx4 v[196:199], v47, s[28:31], s66 offen offset:0 sc1
    buffer_load_dwordx4 v[200:203], v47, s[28:31], s66 offen offset:2048 sc1
    s_waitcnt vmcnt(15)
    v_mfma_f32_32x32x16_bf16 v[96:111], v[208:211], v[140:143], v[96:111]
    s_add_u32 s66, s66, 16384
    buffer_load_dwordx4 v[204:207], v44, s[28:31], s66 offen offset:0 sc1
    v_mfma_f32_32x32x16_bf16 v[112:127], v[212:215], v[140:143], 0
    s_waitcnt vmcnt(15)
    v_mfma_f32_32x32x16_bf16 v[96:111], v[216:219], v[144:147], v[96:111]
    buffer_load_dwordx4 v[140:143], v44, s[28:31], s66 offen offset:2048 sc1
    v_mfma_f32_32x32x16_bf16 v[112:127], v[220:223], v[144:147], v[112:127]
    s_waitcnt vmcnt(15)
    v_mfma_f32_32x32x16_bf16 v[96:111], v[224:227], v[148:151], v[96:111]
    buffer_load_dwordx4 v[144:147], v45, s[28:31], s66 offen offset:0 sc1
    v_mfma_f32_32x32x16_bf16 v[112:127], v[228:231], v[148:151], v[112:127]
    s_waitcnt vmcnt(15)
    v_mfma_f32_32x32x16_bf16 v[96:111], v[232:235], v[152:155], v[96:111]
    ds_read_b64_tr_b16 v[64:65], v40 offset:45056
    ds_read_b64_tr_b16 v[66:67], v40 offset:45568
    buffer_load_dwordx4 v[148:151], v45, s[28:31], s66 offen offset:2048 sc1
    v_mfma_f32_32x32x16_bf16 v[112:127], v[236:239], v[152:155], v[112:127]
    ds_read_b64_tr_b16 v[68:69], v40 offset:45312
    ds_read_b64_tr_b16 v[70:71], v40 offset:45824
    s_waitcnt vmcnt(15)
    v_mfma_f32_32x32x16_bf16 v[96:111], v[240:243], v[156:159], v[96:111]
    ds_read_b64_tr_b16 v[72:73], v40 offset:47104
    ds_read_b64_tr_b16 v[74:75], v40 offset:47616
    buffer_load_dwordx4 v[152:155], v46, s[28:31], s66 offen offset:0 sc1
    v_mfma_f32_32x32x16_bf16 v[112:127], v[244:247], v[156:159], v[112:127]
    ds_read_b64_tr_b16 v[76:77], v40 offset:47360
    ds_read_b64_tr_b16 v[78:79], v40 offset:47872
    s_waitcnt vmcnt(15)
    v_mfma_f32_32x32x16_bf16 v[96:111], v[248:251], v[160:163], v[96:111]
    ds_read_b64_tr_b16 v[48:49], v41 offset:0
    ds_read_b64_tr_b16 v[50:51], v41 offset:512
    buffer_load_dwordx4 v[156:159], v46, s[28:31], s66 offen offset:2048 sc1
    v_mfma_f32_32x32x16_bf16 v[112:127], v[252:255], v[160:163], v[112:127]
    ds_read_b64_tr_b16 v[52:53], v41 offset:256
    ds_read_b64_tr_b16 v[54:55], v41 offset:768
    s_waitcnt vmcnt(15) lgkmcnt(8)
    v_mfma_f32_32x32x16_bf16 v[96:111], v[64:67], v[164:167], v[96:111]
    ds_read_b64_tr_b16 v[56:57], v41 offset:2048
    ds_read_b64_tr_b16 v[58:59], v41 offset:2560
    buffer_load_dwordx4 v[160:163], v47, s[28:31], s66 offen offset:0 sc1
    v_mfma_f32_32x32x16_bf16 v[112:127], v[68:71], v[164:167], v[112:127]
    ds_read_b64_tr_b16 v[60:61], v41 offset:2304
    ds_read_b64_tr_b16 v[62:63], v41 offset:2816
    s_waitcnt vmcnt(15) lgkmcnt(8)
    v_mfma_f32_32x32x16_bf16 v[96:111], v[72:75], v[168:171], v[96:111]
    ds_read_b64_tr_b16 v[64:65], v41 offset:4096
    ds_read_b64_tr_b16 v[66:67], v41 offset:4608
    buffer_load_dwordx4 v[164:167], v47, s[28:31], s66 offen offset:2048 sc1
    v_mfma_f32_32x32x16_bf16 v[112:127], v[76:79], v[168:171], v[112:127]
    ds_read_b64_tr_b16 v[68:69], v41 offset:4352
    ds_read_b64_tr_b16 v[70:71], v41 offset:4864
    s_waitcnt vmcnt(15) lgkmcnt(8)
    v_mfma_f32_32x32x16_bf16 v[96:111], v[48:51], v[172:175], v[96:111]
    ds_read_b64_tr_b16 v[72:73], v41 offset:6144
    ds_read_b64_tr_b16 v[74:75], v41 offset:6656
    s_add_u32 s66, s66, 16384
    buffer_load_dwordx4 v[168:171], v44, s[28:31], s66 offen offset:0 sc1
    v_mfma_f32_32x32x16_bf16 v[112:127], v[52:55], v[172:175], v[112:127]
    ds_read_b64_tr_b16 v[76:77], v41 offset:6400
    ds_read_b64_tr_b16 v[78:79], v41 offset:6912
    s_waitcnt vmcnt(15) lgkmcnt(8)
    v_mfma_f32_32x32x16_bf16 v[96:111], v[56:59], v[176:179], v[96:111]
    ds_read_b64_tr_b16 v[48:49], v41 offset:8192
    ds_read_b64_tr_b16 v[50:51], v41 offset:8704
    buffer_load_dwordx4 v[172:175], v44, s[28:31], s66 offen offset:2048 sc1
    v_mfma_f32_32x32x16_bf16 v[112:127], v[60:63], v[176:179], v[112:127]
    ds_read_b64_tr_b16 v[52:53], v41 offset:8448
    ds_read_b64_tr_b16 v[54:55], v41 offset:8960
    s_waitcnt vmcnt(15) lgkmcnt(8)
    v_mfma_f32_32x32x16_bf16 v[96:111], v[64:67], v[180:183], v[96:111]
    ds_read_b64_tr_b16 v[56:57], v42 offset:0
    ds_read_b64_tr_b16 v[58:59], v42 offset:512
    buffer_load_dwordx4 v[176:179], v45, s[28:31], s66 offen offset:0 sc1
    v_mfma_f32_32x32x16_bf16 v[112:127], v[68:71], v[180:183], v[112:127]
    ds_read_b64_tr_b16 v[60:61], v42 offset:256
    ds_read_b64_tr_b16 v[62:63], v42 offset:768
    s_waitcnt vmcnt(15) lgkmcnt(8)
    v_mfma_f32_32x32x16_bf16 v[96:111], v[72:75], v[184:187], v[96:111]
    ds_read_b64_tr_b16 v[64:65], v42 offset:2048
    ds_read_b64_tr_b16 v[66:67], v42 offset:2560
    buffer_load_dwordx4 v[180:183], v45, s[28:31], s66 offen offset:2048 sc1
    v_mfma_f32_32x32x16_bf16 v[112:127], v[76:79], v[184:187], v[112:127]
    ds_read_b64_tr_b16 v[68:69], v42 offset:2304
    ds_read_b64_tr_b16 v[70:71], v42 offset:2816
    s_waitcnt vmcnt(15) lgkmcnt(8)
    v_mfma_f32_32x32x16_bf16 v[96:111], v[48:51], v[188:191], v[96:111]
    ds_read_b64_tr_b16 v[72:73], v42 offset:4096
    ds_read_b64_tr_b16 v[74:75], v42 offset:4608
    buffer_load_dwordx4 v[184:187], v46, s[28:31], s66 offen offset:0 sc1
    v_mfma_f32_32x32x16_bf16 v[112:127], v[52:55], v[188:191], v[112:127]
    ds_read_b64_tr_b16 v[76:77], v42 offset:4352
    ds_read_b64_tr_b16 v[78:79], v42 offset:4864
    s_waitcnt vmcnt(15) lgkmcnt(8)
    v_mfma_f32_32x32x16_bf16 v[96:111], v[56:59], v[192:195], v[96:111]
    ds_read_b64_tr_b16 v[48:49], v42 offset:6144
    ds_read_b64_tr_b16 v[50:51], v42 offset:6656
    buffer_load_dwordx4 v[188:191], v46, s[28:31], s66 offen offset:2048 sc1
    v_mfma_f32_32x32x16_bf16 v[112:127], v[60:63], v[192:195], v[112:127]
    ds_read_b64_tr_b16 v[52:53], v42 offset:6400
    ds_read_b64_tr_b16 v[54:55], v42 offset:6912
    s_waitcnt vmcnt(15) lgkmcnt(8)
    v_mfma_f32_32x32x16_bf16 v[96:111], v[64:67], v[196:199], v[96:111]
    ds_read_b64_tr_b16 v[56:57], v42 offset:8192
    ds_read_b64_tr_b16 v[58:59], v42 offset:8704
    buffer_load_dwordx4 v[192:195], v47, s[28:31], s66 offen offset:0 sc1
    v_mfma_f32_32x32x16_bf16 v[112:127], v[68:71], v[196:199], v[112:127]
    ds_read_b64_tr_b16 v[60:61], v42 offset:8448
    ds_read_b64_tr_b16 v[62:63], v42 offset:8960
    s_waitcnt vmcnt(15) lgkmcnt(8)
    v_mfma_f32_32x32x16_bf16 v[96:111], v[72:75], v[200:203], v[96:111]
    ds_read_b64_tr_b16 v[64:65], v42 offset:10240
    ds_read_b64_tr_b16 v[66:67], v42 offset:10752
    buffer_load_dwordx4 v[196:199], v47, s[28:31], s66 offen offset:2048 sc1
    v_mfma_f32_32x32x16_bf16 v[112:127], v[76:79], v[200:203], v[112:127]
    ds_read_b64_tr_b16 v[68:69], v42 offset:10496
    ds_read_b64_tr_b16 v[70:71], v42 offset:11008
    s_waitcnt vmcnt(15) lgkmcnt(8)
    v_mfma_f32_32x32x16_bf16 v[96:111], v[48:51], v[204:207], v[96:111]
    ds_read_b64_tr_b16 v[72:73], v42 offset:12288
    ds_read_b64_tr_b16 v[74:75], v42 offset:12800
    s_barrier
    s_mov_b32 s66, s59
    buffer_load_dwordx4 v[200:203], v44, s[28:31], s66 offen offset:0 sc1
    v_mfma_f32_32x32x16_bf16 v[112:127], v[52:55], v[204:207], v[112:127]
    ds_read_b64_tr_b16 v[76:77], v42 offset:12544
    ds_read_b64_tr_b16 v[78:79], v42 offset:13056
    s_waitcnt vmcnt(15) lgkmcnt(8)
    v_mfma_f32_32x32x16_bf16 v[96:111], v[56:59], v[140:143], v[96:111]
    ds_read_b64_tr_b16 v[48:49], v42 offset:14336
    ds_read_b64_tr_b16 v[50:51], v42 offset:14848
    buffer_load_dwordx4 v[204:207], v44, s[28:31], s66 offen offset:2048 sc1
    v_mfma_f32_32x32x16_bf16 v[112:127], v[60:63], v[140:143], v[112:127]
    ds_read_b64_tr_b16 v[52:53], v42 offset:14592
    ds_read_b64_tr_b16 v[54:55], v42 offset:15104
    s_waitcnt vmcnt(15) lgkmcnt(8)
    v_mfma_f32_32x32x16_bf16 v[96:111], v[64:67], v[144:147], v[96:111]
    ds_read_b64_tr_b16 v[56:57], v42 offset:16384
    ds_read_b64_tr_b16 v[58:59], v42 offset:16896
    buffer_load_dwordx4 v[140:143], v45, s[28:31], s66 offen offset:0 sc1
    v_mfma_f32_32x32x16_bf16 v[112:127], v[68:71], v[144:147], v[112:127]
    ds_read_b64_tr_b16 v[60:61], v42 offset:16640
    ds_read_b64_tr_b16 v[62:63], v42 offset:17152
    s_waitcnt vmcnt(15) lgkmcnt(8)
    v_mfma_f32_32x32x16_bf16 v[96:111], v[72:75], v[148:151], v[96:111]
    ds_read_b64_tr_b16 v[64:65], v42 offset:18432
    ds_read_b64_tr_b16 v[66:67], v42 offset:18944
    buffer_load_dwordx4 v[144:147], v45, s[28:31], s66 offen offset:2048 sc1
    v_mfma_f32_32x32x16_bf16 v[112:127], v[76:79], v[148:151], v[112:127]
    ds_read_b64_tr_b16 v[68:69], v42 offset:18688
    ds_read_b64_tr_b16 v[70:71], v42 offset:19200
    s_waitcnt vmcnt(15) lgkmcnt(8)
    v_mfma_f32_32x32x16_bf16 v[96:111], v[48:51], v[152:155], v[96:111]
    ds_read_b64_tr_b16 v[72:73], v42 offset:20480
    ds_read_b64_tr_b16 v[74:75], v42 offset:20992
    buffer_load_dwordx4 v[148:151], v46, s[28:31], s66 offen offset:0 sc1
    v_mfma_f32_32x32x16_bf16 v[112:127], v[52:55], v[152:155], v[112:127]
    ds_read_b64_tr_b16 v[76:77], v42 offset:20736
    ds_read_b64_tr_b16 v[78:79], v42 offset:21248
    s_waitcnt vmcnt(15) lgkmcnt(8)
    v_mfma_f32_32x32x16_bf16 v[96:111], v[56:59], v[156:159], v[96:111]
    ds_read_b64_tr_b16 v[48:49], v42 offset:22528
    ds_read_b64_tr_b16 v[50:51], v42 offset:23040
    buffer_load_dwordx4 v[152:155], v46, s[28:31], s66 offen offset:2048 sc1
    v_mfma_f32_32x32x16_bf16 v[112:127], v[60:63], v[156:159], v[112:127]
    ds_read_b64_tr_b16 v[52:53], v42 offset:22784
    ds_read_b64_tr_b16 v[54:55], v42 offset:23296
    s_waitcnt vmcnt(15) lgkmcnt(8)
    v_mfma_f32_32x32x16_bf16 v[96:111], v[64:67], v[160:163], v[96:111]
    ds_read_b64_tr_b16 v[56:57], v42 offset:24576
    ds_read_b64_tr_b16 v[58:59], v42 offset:25088
    buffer_load_dwordx4 v[156:159], v47, s[28:31], s66 offen offset:0 sc1
    v_mfma_f32_32x32x16_bf16 v[112:127], v[68:71], v[160:163], v[112:127]
    ds_read_b64_tr_b16 v[60:61], v42 offset:24832
    ds_read_b64_tr_b16 v[62:63], v42 offset:25344
    s_waitcnt vmcnt(15) lgkmcnt(8)
    v_mfma_f32_32x32x16_bf16 v[96:111], v[72:75], v[164:167], v[96:111]
    ds_read_b64_tr_b16 v[64:65], v42 offset:26624
    ds_read_b64_tr_b16 v[66:67], v42 offset:27136
    buffer_load_dwordx4 v[160:163], v47, s[28:31], s66 offen offset:2048 sc1
    v_mfma_f32_32x32x16_bf16 v[112:127], v[76:79], v[164:167], v[112:127]
    ds_read_b64_tr_b16 v[68:69], v42 offset:26880
    ds_read_b64_tr_b16 v[70:71], v42 offset:27392
    s_waitcnt vmcnt(15) lgkmcnt(8)
    v_mfma_f32_32x32x16_bf16 v[96:111], v[48:51], v[168:171], v[96:111]
    ds_read_b64_tr_b16 v[72:73], v42 offset:28672
    ds_read_b64_tr_b16 v[74:75], v42 offset:29184
    s_add_u32 s66, s66, 16384
    buffer_load_dwordx4 v[164:167], v44, s[28:31], s66 offen offset:0 sc1
    v_mfma_f32_32x32x16_bf16 v[112:127], v[52:55], v[168:171], v[112:127]
    ds_read_b64_tr_b16 v[76:77], v42 offset:28928
    ds_read_b64_tr_b16 v[78:79], v42 offset:29440
    s_waitcnt vmcnt(15) lgkmcnt(8)
    v_mfma_f32_32x32x16_bf16 v[96:111], v[56:59], v[172:175], v[96:111]
    ds_read_b64_tr_b16 v[48:49], v42 offset:30720
    ds_read_b64_tr_b16 v[50:51], v42 offset:31232
    buffer_load_dwordx4 v[168:171], v44, s[28:31], s66 offen offset:2048 sc1
    v_mfma_f32_32x32x16_bf16 v[112:127], v[60:63], v[172:175], v[112:127]
    ds_read_b64_tr_b16 v[52:53], v42 offset:30976
    ds_read_b64_tr_b16 v[54:55], v42 offset:31488
    s_waitcnt vmcnt(15) lgkmcnt(8)
    v_mfma_f32_32x32x16_bf16 v[96:111], v[64:67], v[176:179], v[96:111]
    ds_read_b64_tr_b16 v[56:57], v40 offset:0
    ds_read_b64_tr_b16 v[58:59], v40 offset:512
    buffer_load_dwordx4 v[172:175], v45, s[28:31], s66 offen offset:0 sc1
    v_mfma_f32_32x32x16_bf16 v[112:127], v[68:71], v[176:179], v[112:127]
    ds_read_b64_tr_b16 v[60:61], v40 offset:256
    ds_read_b64_tr_b16 v[62:63], v40 offset:768
    s_waitcnt vmcnt(15) lgkmcnt(8)
    v_mfma_f32_32x32x16_bf16 v[96:111], v[72:75], v[180:183], v[96:111]
    ds_read_b64_tr_b16 v[64:65], v40 offset:2048
    ds_read_b64_tr_b16 v[66:67], v40 offset:2560
    v_mfma_f32_32x32x16_bf16 v[112:127], v[76:79], v[180:183], v[112:127]
    ds_read_b64_tr_b16 v[68:69], v40 offset:2304
    ds_read_b64_tr_b16 v[70:71], v40 offset:2816
    s_waitcnt vmcnt(14) lgkmcnt(8)
    v_mfma_f32_32x32x16_bf16 v[96:111], v[48:51], v[184:187], v[96:111]
    ds_read_b64_tr_b16 v[72:73], v40 offset:4096
    ds_read_b64_tr_b16 v[74:75], v40 offset:4608
    v_mfma_f32_32x32x16_bf16 v[112:127], v[52:55], v[184:187], v[112:127]
    ds_read_b64_tr_b16 v[76:77], v40 offset:4352
    ds_read_b64_tr_b16 v[78:79], v40 offset:4864
    s_waitcnt vmcnt(13) lgkmcnt(8)
    v_mfma_f32_32x32x16_bf16 v[96:111], v[56:59], v[188:191], v[96:111]
    ds_read_b64_tr_b16 v[48:49], v40 offset:6144
    ds_read_b64_tr_b16 v[50:51], v40 offset:6656
    v_mfma_f32_32x32x16_bf16 v[112:127], v[60:63], v[188:191], v[112:127]
    ds_read_b64_tr_b16 v[52:53], v40 offset:6400
    ds_read_b64_tr_b16 v[54:55], v40 offset:6912
    s_waitcnt vmcnt(12) lgkmcnt(8)
    v_mfma_f32_32x32x16_bf16 v[96:111], v[64:67], v[192:195], v[96:111]
    ds_read_b64_tr_b16 v[56:57], v40 offset:8192
    ds_read_b64_tr_b16 v[58:59], v40 offset:8704
    v_mfma_f32_32x32x16_bf16 v[112:127], v[68:71], v[192:195], v[112:127]
    ds_read_b64_tr_b16 v[60:61], v40 offset:8448
    ds_read_b64_tr_b16 v[62:63], v40 offset:8960
    s_waitcnt vmcnt(11) lgkmcnt(8)
    v_mfma_f32_32x32x16_bf16 v[96:111], v[72:75], v[196:199], v[96:111]
    ds_read_b64_tr_b16 v[64:65], v40 offset:10240
    ds_read_b64_tr_b16 v[66:67], v40 offset:10752
    v_mfma_f32_32x32x16_bf16 v[112:127], v[76:79], v[196:199], v[112:127]
    ds_read_b64_tr_b16 v[68:69], v40 offset:10496
    ds_read_b64_tr_b16 v[70:71], v40 offset:11008
    s_waitcnt vmcnt(10) lgkmcnt(8)
    v_mfma_f32_32x32x16_bf16 v[96:111], v[48:51], v[200:203], v[96:111]
    ds_read_b64_tr_b16 v[72:73], v40 offset:12288
    ds_read_b64_tr_b16 v[74:75], v40 offset:12800
    v_mfma_f32_32x32x16_bf16 v[112:127], v[52:55], v[200:203], v[112:127]
    ds_read_b64_tr_b16 v[76:77], v40 offset:12544
    ds_read_b64_tr_b16 v[78:79], v40 offset:13056
    s_waitcnt vmcnt(9) lgkmcnt(8)
    v_mfma_f32_32x32x16_bf16 v[96:111], v[56:59], v[204:207], v[96:111]
    ds_read_b64_tr_b16 v[48:49], v40 offset:14336
    ds_read_b64_tr_b16 v[50:51], v40 offset:14848
    v_mfma_f32_32x32x16_bf16 v[112:127], v[60:63], v[204:207], v[112:127]
    ds_read_b64_tr_b16 v[52:53], v40 offset:14592
    ds_read_b64_tr_b16 v[54:55], v40 offset:15104
    s_waitcnt vmcnt(8) lgkmcnt(8)
    v_mfma_f32_32x32x16_bf16 v[96:111], v[64:67], v[140:143], v[96:111]
    ds_read_b64_tr_b16 v[56:57], v40 offset:32768
    ds_read_b64_tr_b16 v[58:59], v40 offset:33280
    v_mfma_f32_32x32x16_bf16 v[112:127], v[68:71], v[140:143], v[112:127]
    ds_read_b64_tr_b16 v[60:61], v40 offset:33024
    ds_read_b64_tr_b16 v[62:63], v40 offset:33536
    s_waitcnt vmcnt(7) lgkmcnt(8)
    v_mfma_f32_32x32x16_bf16 v[96:111], v[72:75], v[144:147], v[96:111]
    ds_read_b64_tr_b16 v[64:65], v40 offset:34816
    ds_read_b64_tr_b16 v[66:67], v40 offset:35328
    v_mfma_f32_32x32x16_bf16 v[112:127], v[76:79], v[144:147], v[112:127]
    ds_read_b64_tr_b16 v[68:69], v40 offset:35072
    ds_read_b64_tr_b16 v[70:71], v40 offset:35584
    s_waitcnt vmcnt(6) lgkmcnt(8)
    v_mfma_f32_32x32x16_bf16 v[96:111], v[48:51], v[148:151], v[96:111]
    ds_read_b64_tr_b16 v[72:73], v40 offset:36864
    ds_read_b64_tr_b16 v[74:75], v40 offset:37376
    v_mfma_f32_32x32x16_bf16 v[112:127], v[52:55], v[148:151], v[112:127]
    ds_read_b64_tr_b16 v[76:77], v40 offset:37120
    ds_read_b64_tr_b16 v[78:79], v40 offset:37632
    s_waitcnt vmcnt(5) lgkmcnt(8)
    v_mfma_f32_32x32x16_bf16 v[96:111], v[56:59], v[152:155], v[96:111]
    ds_read_b64_tr_b16 v[48:49], v40 offset:38912
    ds_read_b64_tr_b16 v[50:51], v40 offset:39424
    v_mfma_f32_32x32x16_bf16 v[112:127], v[60:63], v[152:155], v[112:127]
    ds_read_b64_tr_b16 v[52:53], v40 offset:39168
    ds_read_b64_tr_b16 v[54:55], v40 offset:39680
    s_waitcnt vmcnt(4) lgkmcnt(8)
    v_mfma_f32_32x32x16_bf16 v[96:111], v[64:67], v[156:159], v[96:111]
    ds_read_b64_tr_b16 v[56:57], v40 offset:40960
    ds_read_b64_tr_b16 v[58:59], v40 offset:41472
    v_mfma_f32_32x32x16_bf16 v[112:127], v[68:71], v[156:159], v[112:127]
    ds_read_b64_tr_b16 v[60:61], v40 offset:41216
    ds_read_b64_tr_b16 v[62:63], v40 offset:41728
    s_waitcnt vmcnt(3) lgkmcnt(8)
    v_mfma_f32_32x32x16_bf16 v[96:111], v[72:75], v[160:163], v[96:111]
    ds_read_b64_tr_b16 v[64:65], v40 offset:43008
    ds_read_b64_tr_b16 v[66:67], v40 offset:43520
    v_mfma_f32_32x32x16_bf16 v[112:127], v[76:79], v[160:163], v[112:127]
    ds_read_b64_tr_b16 v[68:69], v40 offset:43264
    ds_read_b64_tr_b16 v[70:71], v40 offset:43776
    s_waitcnt vmcnt(2) lgkmcnt(8)
    v_mfma_f32_32x32x16_bf16 v[96:111], v[48:51], v[164:167], v[96:111]
    v_mfma_f32_32x32x16_bf16 v[112:127], v[52:55], v[164:167], v[112:127]
    s_waitcnt vmcnt(1) lgkmcnt(4)
    v_mfma_f32_32x32x16_bf16 v[96:111], v[56:59], v[168:171], v[96:111]
    v_mfma_f32_32x32x16_bf16 v[112:127], v[60:63], v[168:171], v[112:127]
    s_waitcnt vmcnt(0) lgkmcnt(0)
    v_mfma_f32_32x32x16_bf16 v[96:111], v[64:67], v[172:175], v[96:111]
    v_mfma_f32_32x32x16_bf16 v[112:127], v[68:71], v[172:175], v[112:127]
    v_lshlrev_b32 v208, 16, v20
    v_and_b32 v209, 0xffff0000, v20
    v_lshlrev_b32 v210, 16, v21
    v_and_b32 v211, 0xffff0000, v21
    v_lshlrev_b32 v212, 16, v22
    v_and_b32 v213, 0xffff0000, v22
    v_lshlrev_b32 v214, 16, v23
    v_and_b32 v215, 0xffff0000, v23
    v_lshlrev_b32 v216, 16, v24
    v_and_b32 v217, 0xffff0000, v24
    v_lshlrev_b32 v218, 16, v25
    v_and_b32 v219, 0xffff0000, v25
    ds_write_b128 v43, v[112:115] offset:0
    ds_write_b128 v43, v[116:119] offset:1024
    ds_write_b128 v43, v[120:123] offset:2048
    ds_write_b128 v43, v[124:127] offset:3072
    v_lshlrev_b32 v220, 16, v26
    v_and_b32 v221, 0xffff0000, v26
    v_lshlrev_b32 v222, 16, v27
    v_and_b32 v223, 0xffff0000, v27
    s_waitcnt lgkmcnt(0)
    s_barrier
    ds_read_b128 v[80:83], v128 offset:0
    ds_read_b64_tr_b16 v[240:241], v129 offset:0
    ds_read_b128 v[84:87], v128 offset:1024
    ds_read_b64_tr_b16 v[242:243], v129 offset:512
    ds_read_b128 v[88:91], v128 offset:2048
    ds_read_b64_tr_b16 v[244:245], v129 offset:1024
    ds_read_b128 v[92:95], v128 offset:3072
    ds_read_b64_tr_b16 v[246:247], v129 offset:1536
    s_waitcnt lgkmcnt(6)
    v_pk_add_f32 v[96:97], v[96:97], v[80:81]
    v_pk_add_f32 v[98:99], v[98:99], v[82:83]
    v_lshlrev_b32 v224, 16, v240
    v_lshlrev_b32 v226, 16, v241
    v_pk_mul_f32 v[28:29], v[96:97], v[12:13] op_sel_hi:[1,0]
    v_pk_mul_f32 v[30:31], v[98:99], v[12:13] op_sel_hi:[1,0]
    v_and_b32 v225, 0xffff0000, v240
    v_and_b32 v227, 0xffff0000, v241
    v_exp_f32 v28, v28
    v_exp_f32 v30, v30
    v_exp_f32 v29, v29
    v_exp_f32 v31, v31
    v_pk_mul_f32 v[96:97], v[96:97], v[224:225]
    v_pk_mul_f32 v[98:99], v[98:99], v[226:227]
    v_pk_add_f32 v[28:29], v[28:29], 1.0 op_sel_hi:[1,0]
    v_pk_add_f32 v[30:31], v[30:31], 1.0 op_sel_hi:[1,0]
    v_rcp_f32 v28, v28
    v_rcp_f32 v30, v30
    v_rcp_f32 v29, v29
    v_rcp_f32 v31, v31
    v_pk_fma_f32 v[96:97], v[96:97], v[28:29], v[208:209]
    v_pk_fma_f32 v[98:99], v[98:99], v[30:31], v[210:211]
    v_cvt_pk_bf16_f32 v32, v96, v97
    v_cvt_pk_bf16_f32 v33, v98, v99
    s_waitcnt lgkmcnt(4)
    v_pk_add_f32 v[100:101], v[100:101], v[84:85]
    v_pk_add_f32 v[102:103], v[102:103], v[86:87]
    v_lshlrev_b32 v228, 16, v242
    v_lshlrev_b32 v230, 16, v243
    v_pk_mul_f32 v[28:29], v[100:101], v[12:13] op_sel_hi:[1,0]
    v_pk_mul_f32 v[30:31], v[102:103], v[12:13] op_sel_hi:[1,0]
    v_and_b32 v229, 0xffff0000, v242
    v_and_b32 v231, 0xffff0000, v243
    v_exp_f32 v28, v28
    v_exp_f32 v30, v30
    v_exp_f32 v29, v29
    v_exp_f32 v31, v31
    v_pk_mul_f32 v[100:101], v[100:101], v[228:229]
    v_pk_mul_f32 v[102:103], v[102:103], v[230:231]
    v_pk_add_f32 v[28:29], v[28:29], 1.0 op_sel_hi:[1,0]
    v_pk_add_f32 v[30:31], v[30:31], 1.0 op_sel_hi:[1,0]
    v_rcp_f32 v28, v28
    v_rcp_f32 v30, v30
    v_rcp_f32 v29, v29
    v_rcp_f32 v31, v31
    v_pk_fma_f32 v[100:101], v[100:101], v[28:29], v[212:213]
    v_pk_fma_f32 v[102:103], v[102:103], v[30:31], v[214:215]
    v_cvt_pk_bf16_f32 v34, v100, v101
    v_cvt_pk_bf16_f32 v35, v102, v103
    buffer_store_dwordx4 v[32:35], v130, s[32:35], s58 offen offset:0
    s_waitcnt lgkmcnt(2)
    v_pk_add_f32 v[104:105], v[104:105], v[88:89]
    v_pk_add_f32 v[106:107], v[106:107], v[90:91]
    v_lshlrev_b32 v232, 16, v244
    v_lshlrev_b32 v234, 16, v245
    v_pk_mul_f32 v[28:29], v[104:105], v[12:13] op_sel_hi:[1,0]
    v_pk_mul_f32 v[30:31], v[106:107], v[12:13] op_sel_hi:[1,0]
    v_and_b32 v233, 0xffff0000, v244
    v_and_b32 v235, 0xffff0000, v245
    v_exp_f32 v28, v28
    v_exp_f32 v30, v30
    v_exp_f32 v29, v29
    v_exp_f32 v31, v31
    v_pk_mul_f32 v[104:105], v[104:105], v[232:233]
    v_pk_mul_f32 v[106:107], v[106:107], v[234:235]
    v_pk_add_f32 v[28:29], v[28:29], 1.0 op_sel_hi:[1,0]
    v_pk_add_f32 v[30:31], v[30:31], 1.0 op_sel_hi:[1,0]
    v_rcp_f32 v28, v28
    v_rcp_f32 v30, v30
    v_rcp_f32 v29, v29
    v_rcp_f32 v31, v31
    v_pk_fma_f32 v[104:105], v[104:105], v[28:29], v[216:217]
    v_pk_fma_f32 v[106:107], v[106:107], v[30:31], v[218:219]
    v_cvt_pk_bf16_f32 v36, v104, v105
    v_cvt_pk_bf16_f32 v37, v106, v107
    s_waitcnt lgkmcnt(0)
    v_pk_add_f32 v[108:109], v[108:109], v[92:93]
    v_pk_add_f32 v[110:111], v[110:111], v[94:95]
    v_lshlrev_b32 v236, 16, v246
    v_lshlrev_b32 v238, 16, v247
    v_pk_mul_f32 v[28:29], v[108:109], v[12:13] op_sel_hi:[1,0]
    v_pk_mul_f32 v[30:31], v[110:111], v[12:13] op_sel_hi:[1,0]
    v_and_b32 v237, 0xffff0000, v246
    v_and_b32 v239, 0xffff0000, v247
    v_exp_f32 v28, v28
    v_exp_f32 v30, v30
    v_exp_f32 v29, v29
    v_exp_f32 v31, v31
    v_pk_mul_f32 v[108:109], v[108:109], v[236:237]
    v_pk_mul_f32 v[110:111], v[110:111], v[238:239]
    v_pk_add_f32 v[28:29], v[28:29], 1.0 op_sel_hi:[1,0]
    v_pk_add_f32 v[30:31], v[30:31], 1.0 op_sel_hi:[1,0]
    v_rcp_f32 v28, v28
    v_rcp_f32 v30, v30
    v_rcp_f32 v29, v29
    v_rcp_f32 v31, v31
    v_pk_fma_f32 v[108:109], v[108:109], v[28:29], v[220:221]
    v_pk_fma_f32 v[110:111], v[110:111], v[30:31], v[222:223]
    v_cvt_pk_bf16_f32 v38, v108, v109
    v_cvt_pk_bf16_f32 v39, v110, v111
    buffer_store_dwordx4 v[36:39], v130, s[32:35], s58 offen offset:16
    s_endpgm
L_end:
    s_endpgm
.section .rodata,"a"
.p2align 6
.amdhsa_kernel recurrent_scan__spectral_fnet__mixer_s_mlp__prompt_kernel
  .amdhsa_next_free_vgpr 256
  .amdhsa_next_free_sgpr 102
  .amdhsa_accum_offset 256
  .amdhsa_group_segment_fixed_size 0
  .amdhsa_kernarg_size 104
  .amdhsa_user_sgpr_count 2
  .amdhsa_user_sgpr_kernarg_segment_ptr 1
  .amdhsa_system_sgpr_workgroup_id_x 1
.end_amdhsa_kernel
```
